```python
import torch

def _softmax(x, axis=-1):
    return torch.softmax(x, dim=axis)
def _gelu(x):
    return torch.nn.functional.gelu(x, approximate="tanh")
def _silu(x):
    return torch.nn.functional.silu(x)
def _sigmoid(x):
    return torch.sigmoid(x)
def _layernorm(x, axis=-1, eps=1e-5):
    m = x.mean(dim=axis, keepdim=True)
    v = x.var(dim=axis, keepdim=True, unbiased=False)
    return (x - m) / torch.sqrt(v + eps)
def _scatter_add(tgt, idx, src, axis=0):
    return tgt.clone().index_add_(axis, idx, src)
def _segment_sum(src, seg, n):
    out = torch.zeros((n,) + src.shape[1:], dtype=src.dtype)
    return out.index_add_(0, seg, src)
def _pad(x, pw):
    flat = tuple(v for pair in reversed(pw) for v in pair)
    return torch.nn.functional.pad(x, flat)

kernel_name = 'concat_heads__ssm_conv_s4__softmax_full_mha__prompt'

def setup_inputs():

    _w = (lambda a: (lambda t: t.to(torch.bfloat16) if t.is_floating_point() else t)(torch.as_tensor(a)))
    def _A_setup():
        B, L, D, N = 1, 2048, 512, 128
        A_re = -(lambda _x: torch.exp(torch.as_tensor(_x)))((lambda *s: torch.randn(*s, dtype=torch.bfloat16) * 6.4)(D, N))
        A_im = torch.pi * (lambda *s: torch.randn(*s, dtype=torch.bfloat16) * 0.1)(D, N)
        B_re = (lambda *s: torch.randn(*s, dtype=torch.bfloat16) * 0.2)(D, N)
        B_im = (lambda *s: torch.randn(*s, dtype=torch.bfloat16) * 0.2)(D, N)
        C_re = (lambda *s: torch.randn(*s, dtype=torch.bfloat16) * 0.2)(D, N)
        C_im = (lambda *s: torch.randn(*s, dtype=torch.bfloat16) * 0.2)(D, N)
        log_dt = (lambda *s: torch.randn(*s, dtype=torch.bfloat16) * 0.1)(D) * 0.5 - 4.0
        Dskip = (lambda *s: torch.randn(*s, dtype=torch.bfloat16) * 0.1)(D)
        return {
            "u": _w((lambda *s: torch.randn(*s, dtype=torch.bfloat16) * 0.05)(B, L, D)),
            "A_re": _w(A_re),
            "A_im": _w(A_im),
            "B_re": _w(B_re),
            "B_im": _w(B_im),
            "C_re": _w(C_re),
            "C_im": _w(C_im),
            "log_dt": _w(log_dt),
            "Dskip": _w(Dskip),
        }
    _A_in = _A_setup()

    def _B_setup():
        B, S, D = 1, 2048, 512
        return {
            "x": _w((lambda *s: torch.randn(*s, dtype=torch.bfloat16) * 0.2)(B, S, D)),
            "wqkv": _w((lambda *s: torch.randn(*s, dtype=torch.bfloat16) * 0.2)(D, 3 * D)),
            "wo": _w((lambda *s: torch.randn(*s, dtype=torch.bfloat16) * 0.05)(D, D)),
        }
    _B_in = _B_setup()

    return {
        "A_u": _A_in["u"],
        "A_A_re": _A_in["A_re"],
        "A_A_im": _A_in["A_im"],
        "A_B_re": _A_in["B_re"],
        "A_B_im": _A_in["B_im"],
        "A_C_re": _A_in["C_re"],
        "A_C_im": _A_in["C_im"],
        "A_log_dt": _A_in["log_dt"],
        "A_Dskip": _A_in["Dskip"],
        "B_x": _B_in["x"],
        "B_wqkv": _B_in["wqkv"],
        "B_wo": _B_in["wo"],
    }

def reference(A_u, A_A_re, A_A_im, A_B_re, A_B_im, A_C_re, A_C_im, A_log_dt, A_Dskip, B_x, B_wqkv, B_wo):
    def _A_ref(u, A_re, A_im, B_re, B_im, C_re, C_im, log_dt, Dskip):
        Bsz, L, D = u.shape
        dt = torch.exp(log_dt)[:, None]
        A = A_re + 1j * A_im
        Bc = B_re + 1j * B_im
        Cc = C_re + 1j * C_im
        logdA = dt * A
        dB = dt * Bc
        l = (lambda x, dt: x.to(dt))(torch.arange(L), A_re.dtype)
        P = torch.exp(logdA[:, :, None] * l[None, None, :])
        K = torch.einsum("dn,dnl,dn->dl", Cc, P, dB).real
        L2 = 2 * L
        Kp = _pad(K, ((0, 0), (0, L)))
        up = (lambda x, *d: x.permute(*d))(u, 0, 2, 1)
        up = _pad(up, ((0, 0), (0, 0), (0, L)))
        Kf = (lambda x, axes=(-2,-1): torch.fft.rfft2(x.float(), dim=axes))(Kp[:, None, :], axes=(-2, -1))
        Uf = (lambda x, axes=(-2,-1): torch.fft.rfft2(x.float(), dim=axes))(up[:, :, None, :], axes=(-2, -1))
        Yf = Uf * Kf[None, :, :, :]
        y = (lambda x, s, axes=(-2,-1): torch.fft.irfft2(x, s=s, dim=axes).to(torch.bfloat16))(Yf, (1, L2), axes=(-2, -1))[:, :, 0, :L]
        y = (lambda x, *d: x.permute(*d))(y, 0, 2, 1) + u * Dskip[None, None, :]
        return y

    def _B_ref(x, wqkv, wo):
        B, S, D = x.shape
        H = 32; Dh = D // H
        qkv = (lambda x, *d: x.permute(*d))((x @ wqkv).reshape(B, S, 3, H, Dh), 2, 0, 3, 1, 4)
        q, k, v = qkv[0], qkv[1], qkv[2]
        scale = Dh ** -0.5
        scores = torch.einsum("bhqd,bhkd->bhqk", q, k) * scale
        p = _softmax(scores, axis=-1)
        o = torch.einsum("bhqk,bhkd->bhqd", p, v)
        return (lambda x, *d: x.permute(*d))(o, 0, 2, 1, 3).reshape(B, S, D) @ wo

    a = _A_ref(A_u, A_A_re, A_A_im, A_B_re, A_B_im, A_C_re, A_C_im, A_log_dt, A_Dskip)
    b = _B_ref(B_x, B_wqkv, B_wo)
    return torch.concatenate([a, b], axis=-1)
```

```asm
; @launch grid=(256,1,1) block=(768,1,1) lds=163840
.amdgcn_target "amdgcn-amd-amdhsa--gfx950"
.text
.globl concat_heads__ssm_conv_s4__softmax_full_mha__prompt_kernel
.p2align 8
.type concat_heads__ssm_conv_s4__softmax_full_mha__prompt_kernel,@function
concat_heads__ssm_conv_s4__softmax_full_mha__prompt_kernel:
    s_cmp_ge_u32 s2, 256
    s_cbranch_scc1 L_end
    s_load_dwordx16 s[16:31], s[0:1], 8
    s_load_dwordx4 s[32:35], s[0:1], 72
    s_load_dwordx4 s[36:39], s[0:1], 104
    v_lshrrev_b32 v3, 6, v0
    v_and_b32 v4, 63, v0
    s_and_b32 s44, s2, 7
    s_lshr_b32 s45, s2, 3
    v_readfirstlane_b32 s3, v3
    s_lshl_b32 s60, s44, 6
    s_lshl_b32 s46, s45, 1
    s_add_u32 s60, s60, s46
    s_lshl_b32 s46, s60, 8
    v_lshl_add_u32 v5, v0, 1, s46
    s_lshr_b32 s4, s44, 1
    s_lshl_b32 s4, s4, 3
    s_and_b32 s46, s45, 7
    s_add_u32 s4, s4, s46
    s_and_b32 s5, s44, 1
    s_lshl_b32 s5, s5, 2
    s_lshr_b32 s47, s45, 3
    s_add_u32 s5, s5, s47
    s_lshl_b32 s47, s47, 1
    s_add_u32 s6, s46, s47
    s_cmp_ge_u32 s3, 4
    s_cbranch_scc1 L_gemm
    s_lshr_b32 s61, s3, 1
    s_add_u32 s52, s60, s61
    s_lshl_b32 s46, s52, 1
    v_mov_b32 v19, s46
    s_and_b32 s53, s3, 1
    s_waitcnt lgkmcnt(0)
    global_load_ushort v26, v19, s[28:29]
    global_load_ushort v20, v5, s[16:17]
    global_load_ushort v21, v5, s[18:19]
    global_load_ushort v22, v5, s[20:21]
    global_load_ushort v23, v5, s[22:23]
    global_load_ushort v24, v5, s[24:25]
    global_load_ushort v25, v5, s[26:27]
    global_load_ushort v27, v19, s[30:31]
    s_getpc_b64 s[40:41]
    v_and_b32 v1, 7, v0
    v_lshlrev_b32 v1, 7, v1
    s_lshl_b32 s46, s45, 10
    v_add_u32 v1, s46, v1
    global_load_dword v2, v1, s[40:41]
    s_branch L_gen2
L_gemm:
    s_cmp_ge_u32 s3, 8
    s_cbranch_scc1 L_mm
    s_setprio 2
    s_sub_u32 s61, s3, 4
    v_lshrrev_b32 v10, 3, v4
    v_lshrrev_b32 v11, 4, v4
    v_and_b32 v12, 7, v4
    v_xor_b32 v13, v12, v11
    s_lshl_b32 s47, s61, 4
    v_add_u32 v10, s47, v10
    s_lshl_b32 s46, s4, 16
    v_lshl_add_u32 v14, v10, 10, s46
    v_lshl_add_u32 v6, v13, 4, v14
    v_xor_b32 v7, 64, v6
    v_add_u32 v7, 0x1c00, v7
    v_lshlrev_b32 v16, 10, v10
    v_lshl_add_u32 v16, v12, 4, v16
    v_mul_u32_u24 v10, 3072, v10
    v_and_b32 v11, 1, v11
    v_lshlrev_b32 v11, 2, v11
    v_xor_b32 v12, v12, v11
    v_lshl_add_u32 v8, v12, 4, v10
    s_lshl_b32 s46, s5, 7
    v_add_u32 v8, s46, v8
    v_add_u32 v9, 23552, v8
    s_lshl_b32 s48, s61, 11
    s_waitcnt lgkmcnt(0)
    s_mov_b32 s16, s32
    s_mov_b32 s17, s33
    s_mov_b32 s18, 0x200000
    s_mov_b32 s19, 0x00020000
    s_mov_b32 s12, s34
    s_mov_b32 s13, s35
    s_mov_b32 s14, 0x180000
    s_mov_b32 s15, 0x00020000
    s_add_u32 s50, s6, 0
    s_and_b32 s50, s50, 7
    s_mul_i32 s49, s50, 196608
    s_add_u32 m0, s48, 0
    s_lshl_b32 s50, s50, 7
    buffer_load_dwordx4 v6, s[16:19], s50 offen lds
    buffer_load_dwordx4 v7, s[16:19], s50 offen offset:1024 lds
    s_add_u32 m0, s48, 8192
    s_add_u32 s49, s49, 1024
    buffer_load_dwordx4 v8, s[12:15], s49 offen lds
    buffer_load_dwordx4 v9, s[12:15], s49 offen offset:1024 lds
    s_add_u32 s50, s6, 1
    s_and_b32 s50, s50, 7
    s_mul_i32 s49, s50, 196608
    s_add_u32 m0, s48, 16384
    s_lshl_b32 s50, s50, 7
    buffer_load_dwordx4 v6, s[16:19], s50 offen lds
    buffer_load_dwordx4 v7, s[16:19], s50 offen offset:1024 lds
    s_add_u32 m0, s48, 24576
    s_add_u32 s49, s49, 1024
    buffer_load_dwordx4 v8, s[12:15], s49 offen lds
    buffer_load_dwordx4 v9, s[12:15], s49 offen offset:1024 lds
    s_load_dwordx2 s[20:21], s[0:1], 0
    s_mov_b32 s8, s38
    s_mov_b32 s9, s39
    s_mov_b32 s10, 0x2000000
    s_mov_b32 s11, 0x00020000
    s_lshl_b32 s46, s45, 16
    s_lshl_b32 s47, s44, 7
    s_add_u32 s58, s46, s47
    s_add_u32 s59, s48, 74752
    v_add_u32 v17, 0x1c00, v16
    v_mov_b32 v12, 94208
    s_waitcnt lgkmcnt(0)
    s_mov_b32 s60, s20
    s_mov_b32 s61, s21
    s_mov_b32 s62, 0x200000
    s_mov_b32 s63, 0x00020000
    s_waitcnt vmcnt(4)
    s_barrier
    s_add_u32 s50, s6, 2
    s_and_b32 s50, s50, 7
    s_mul_i32 s49, s50, 196608
    s_add_u32 m0, s48, 32768
    s_lshl_b32 s50, s50, 7
    buffer_load_dwordx4 v6, s[16:19], s50 offen lds
    buffer_load_dwordx4 v7, s[16:19], s50 offen offset:1024 lds
    s_add_u32 m0, s48, 40960
    s_add_u32 s49, s49, 1024
    buffer_load_dwordx4 v8, s[12:15], s49 offen lds
    buffer_load_dwordx4 v9, s[12:15], s49 offen offset:1024 lds
    s_add_u32 s50, s6, 3
    s_and_b32 s50, s50, 7
    s_mul_i32 s49, s50, 196608
    s_add_u32 m0, s48, 49152
    s_lshl_b32 s50, s50, 7
    buffer_load_dwordx4 v6, s[16:19], s50 offen lds
    buffer_load_dwordx4 v7, s[16:19], s50 offen offset:1024 lds
    s_add_u32 m0, s48, 57344
    s_add_u32 s49, s49, 1024
    buffer_load_dwordx4 v8, s[12:15], s49 offen lds
    buffer_load_dwordx4 v9, s[12:15], s49 offen offset:1024 lds
    s_waitcnt vmcnt(8)
    s_barrier
    s_add_u32 s50, s6, 4
    s_and_b32 s50, s50, 7
    s_mul_i32 s49, s50, 196608
    s_add_u32 m0, s48, 65536
    s_lshl_b32 s50, s50, 7
    buffer_load_dwordx4 v6, s[16:19], s50 offen lds
    buffer_load_dwordx4 v7, s[16:19], s50 offen offset:1024 lds
    s_add_u32 m0, s48, 73728
    s_add_u32 s49, s49, 1024
    buffer_load_dwordx4 v8, s[12:15], s49 offen lds
    buffer_load_dwordx4 v9, s[12:15], s49 offen offset:1024 lds
    s_add_u32 s50, s6, 5
    s_and_b32 s50, s50, 7
    s_mul_i32 s49, s50, 196608
    s_add_u32 m0, s48, 81920
    s_lshl_b32 s50, s50, 7
    buffer_load_dwordx4 v6, s[16:19], s50 offen lds
    buffer_load_dwordx4 v7, s[16:19], s50 offen offset:1024 lds
    s_add_u32 m0, s48, 90112
    s_add_u32 s49, s49, 1024
    buffer_load_dwordx4 v8, s[12:15], s49 offen lds
    buffer_load_dwordx4 v9, s[12:15], s49 offen offset:1024 lds
    s_waitcnt vmcnt(12)
    s_barrier
    s_add_u32 s50, s6, 6
    s_and_b32 s50, s50, 7
    s_mul_i32 s49, s50, 196608
    s_add_u32 m0, s48, 0
    s_lshl_b32 s50, s50, 7
    buffer_load_dwordx4 v6, s[16:19], s50 offen lds
    buffer_load_dwordx4 v7, s[16:19], s50 offen offset:1024 lds
    s_add_u32 m0, s48, 8192
    s_add_u32 s49, s49, 1024
    buffer_load_dwordx4 v8, s[12:15], s49 offen lds
    buffer_load_dwordx4 v9, s[12:15], s49 offen offset:1024 lds
    s_waitcnt vmcnt(12)
    s_barrier
    s_add_u32 s50, s6, 7
    s_and_b32 s50, s50, 7
    s_mul_i32 s49, s50, 196608
    s_add_u32 m0, s48, 16384
    s_lshl_b32 s50, s50, 7
    buffer_load_dwordx4 v6, s[16:19], s50 offen lds
    buffer_load_dwordx4 v7, s[16:19], s50 offen offset:1024 lds
    s_add_u32 m0, s48, 24576
    s_add_u32 s49, s49, 1024
    buffer_load_dwordx4 v8, s[12:15], s49 offen lds
    buffer_load_dwordx4 v9, s[12:15], s49 offen offset:1024 lds
    s_waitcnt vmcnt(12)
    s_barrier
    s_add_u32 s50, s6, 0
    s_and_b32 s50, s50, 7
    s_mul_i32 s49, s50, 196608
    s_add_u32 m0, s48, 32768
    s_add_u32 s49, s49, 2048
    buffer_load_dwordx4 v8, s[12:15], s49 offen lds
    buffer_load_dwordx4 v9, s[12:15], s49 offen offset:1024 lds
    s_add_u32 s50, s6, 1
    s_and_b32 s50, s50, 7
    s_mul_i32 s49, s50, 196608
    s_add_u32 m0, s48, 40960
    s_add_u32 s49, s49, 2048
    buffer_load_dwordx4 v8, s[12:15], s49 offen lds
    buffer_load_dwordx4 v9, s[12:15], s49 offen offset:1024 lds
    s_waitcnt vmcnt(12)
    s_barrier
    s_add_u32 s50, s6, 2
    s_and_b32 s50, s50, 7
    s_mul_i32 s49, s50, 196608
    s_add_u32 m0, s48, 49152
    s_add_u32 s49, s49, 2048
    buffer_load_dwordx4 v8, s[12:15], s49 offen lds
    buffer_load_dwordx4 v9, s[12:15], s49 offen offset:1024 lds
    s_add_u32 s50, s6, 3
    s_and_b32 s50, s50, 7
    s_mul_i32 s49, s50, 196608
    s_add_u32 m0, s48, 57344
    s_add_u32 s49, s49, 2048
    buffer_load_dwordx4 v8, s[12:15], s49 offen lds
    buffer_load_dwordx4 v9, s[12:15], s49 offen offset:1024 lds
    s_waitcnt vmcnt(12)
    s_barrier
    s_add_u32 s50, s6, 4
    s_and_b32 s50, s50, 7
    s_mul_i32 s49, s50, 196608
    s_add_u32 m0, s48, 65536
    s_add_u32 s49, s49, 2048
    buffer_load_dwordx4 v8, s[12:15], s49 offen lds
    buffer_load_dwordx4 v9, s[12:15], s49 offen offset:1024 lds
    s_add_u32 s50, s6, 5
    s_and_b32 s50, s50, 7
    s_mul_i32 s49, s50, 196608
    s_add_u32 m0, s48, 73728
    s_add_u32 s49, s49, 2048
    buffer_load_dwordx4 v8, s[12:15], s49 offen lds
    buffer_load_dwordx4 v9, s[12:15], s49 offen offset:1024 lds
    s_waitcnt vmcnt(12)
    s_barrier
    s_add_u32 s50, s6, 6
    s_and_b32 s50, s50, 7
    s_mul_i32 s49, s50, 196608
    s_add_u32 m0, s48, 81920
    s_add_u32 s49, s49, 2048
    buffer_load_dwordx4 v8, s[12:15], s49 offen lds
    buffer_load_dwordx4 v9, s[12:15], s49 offen offset:1024 lds
    s_add_u32 s50, s6, 7
    s_and_b32 s50, s50, 7
    s_mul_i32 s49, s50, 196608
    s_add_u32 m0, s48, 90112
    s_add_u32 s49, s49, 2048
    buffer_load_dwordx4 v8, s[12:15], s49 offen lds
    buffer_load_dwordx4 v9, s[12:15], s49 offen offset:1024 lds
    s_waitcnt vmcnt(12)
    s_barrier
    s_add_u32 s50, s6, 0
    s_and_b32 s50, s50, 7
    s_mul_i32 s49, s50, 196608
    s_add_u32 m0, s48, 0
    s_add_u32 s49, s49, 0
    buffer_load_dwordx4 v8, s[12:15], s49 offen lds
    buffer_load_dwordx4 v9, s[12:15], s49 offen offset:1024 lds
    s_add_u32 s50, s6, 1
    s_and_b32 s50, s50, 7
    s_mul_i32 s49, s50, 196608
    s_add_u32 m0, s48, 8192
    s_add_u32 s49, s49, 0
    buffer_load_dwordx4 v8, s[12:15], s49 offen lds
    buffer_load_dwordx4 v9, s[12:15], s49 offen offset:1024 lds
    s_waitcnt vmcnt(12)
    s_barrier
    s_add_u32 s50, s6, 2
    s_and_b32 s50, s50, 7
    s_mul_i32 s49, s50, 196608
    s_add_u32 m0, s48, 16384
    s_add_u32 s49, s49, 0
    buffer_load_dwordx4 v8, s[12:15], s49 offen lds
    buffer_load_dwordx4 v9, s[12:15], s49 offen offset:1024 lds
    s_add_u32 s50, s6, 3
    s_and_b32 s50, s50, 7
    s_mul_i32 s49, s50, 196608
    s_add_u32 m0, s48, 24576
    s_add_u32 s49, s49, 0
    buffer_load_dwordx4 v8, s[12:15], s49 offen lds
    buffer_load_dwordx4 v9, s[12:15], s49 offen offset:1024 lds
    s_waitcnt vmcnt(12)
    s_barrier
    s_add_u32 s50, s6, 4
    s_and_b32 s50, s50, 7
    s_mul_i32 s49, s50, 196608
    s_add_u32 m0, s48, 32768
    s_add_u32 s49, s49, 0
    buffer_load_dwordx4 v8, s[12:15], s49 offen lds
    buffer_load_dwordx4 v9, s[12:15], s49 offen offset:1024 lds
    s_add_u32 s50, s6, 5
    s_and_b32 s50, s50, 7
    s_mul_i32 s49, s50, 196608
    s_add_u32 m0, s48, 40960
    s_add_u32 s49, s49, 0
    buffer_load_dwordx4 v8, s[12:15], s49 offen lds
    buffer_load_dwordx4 v9, s[12:15], s49 offen offset:1024 lds
    s_waitcnt vmcnt(12)
    s_barrier
    s_add_u32 s50, s6, 6
    s_and_b32 s50, s50, 7
    s_mul_i32 s49, s50, 196608
    s_add_u32 m0, s48, 49152
    s_add_u32 s49, s49, 0
    buffer_load_dwordx4 v8, s[12:15], s49 offen lds
    buffer_load_dwordx4 v9, s[12:15], s49 offen offset:1024 lds
    s_add_u32 s50, s6, 7
    s_and_b32 s50, s50, 7
    s_mul_i32 s49, s50, 196608
    s_add_u32 m0, s48, 57344
    s_add_u32 s49, s49, 0
    buffer_load_dwordx4 v8, s[12:15], s49 offen lds
    buffer_load_dwordx4 v9, s[12:15], s49 offen offset:1024 lds
    s_waitcnt vmcnt(12)
    s_barrier
    s_lshr_b32 s19, s3, 3
    s_and_b32 s18, s3, 1
    s_lshl_b32 s24, s19, 1
    s_add_u32 s18, s18, s24
    s_bfe_u32 s24, s3, 0x10001
    v_lshlrev_b32 v5, 4, v4
    s_lshl_b32 s26, s18, 10
    s_add_u32 s26, s26, 65536
    s_lshl_b32 s27, s24, 12
    s_add_u32 s26, s26, s27
    v_add_u32 v13, s26, v5
    s_lshl_b32 s27, s5, 2
    s_add_u32 s18, s18, s27
    s_lshl_b32 s22, s18, 16
    s_add_u32 s27, s22, 2097152
    v_add_u32 v14, s27, v5
    s_lshl_b32 s36, s24, 10
    s_mov_b32 s37, s36
    v_lshrrev_b32 v6, 5, v4
    v_and_b32 v7, 15, v4
    v_lshlrev_b32 v7, 4, v7
    v_lshl_add_u32 v7, v6, 8, v7
    s_add_u32 s27, s22, 4194304
    v_add_u32 v15, s27, v7
    v_and_b32 v6, 31, v4
    v_cmp_eq_u32 vcc, 16, v6
    v_cmp_eq_u32 s[28:29], 20, v6
    s_mov_b32 s30, 0x3f803f80
    s_or_b64 vcc, vcc, s[28:29]
    v_mov_b32 v7, s30
    s_mov_b32 s40, 0xffff
    s_mov_b32 s41, 0xffff
    v_cndmask_b32 v6, 0, v7, vcc
    v_mov_b32 v120, v6
    v_mov_b32 v121, v6
    v_mov_b32 v122, v6
    v_mov_b32 v123, v6
    v_mov_b32 v124, v6
    v_mov_b32 v125, v6
    v_mov_b32 v126, v6
    v_mov_b32 v127, v6
    v_mov_b32 v128, v6
    v_mov_b32 v129, v6
    v_mov_b32 v130, v6
    v_mov_b32 v131, v6
    v_mov_b32 v132, v6
    v_mov_b32 v133, v6
    v_mov_b32 v134, v6
    v_mov_b32 v135, v6
    v_mov_b32 v136, v6
    v_mov_b32 v137, v6
    v_mov_b32 v138, v6
    v_mov_b32 v139, v6
    v_mov_b32 v140, v6
    v_mov_b32 v141, v6
    v_mov_b32 v142, v6
    v_mov_b32 v143, v6
    v_mov_b32 v144, v6
    v_mov_b32 v145, v6
    v_mov_b32 v146, v6
    v_mov_b32 v147, v6
    v_mov_b32 v148, v6
    v_mov_b32 v149, v6
    v_mov_b32 v150, v6
    v_mov_b32 v151, v6
    v_mov_b32 v64, 0
    v_mov_b32 v65, 0
    v_mov_b32 v66, 0
    v_mov_b32 v67, 0
    v_mov_b32 v68, 0
    v_mov_b32 v69, 0
    v_mov_b32 v70, 0
    v_mov_b32 v71, 0
    v_mov_b32 v72, 0
    v_mov_b32 v73, 0
    v_mov_b32 v74, 0
    v_mov_b32 v75, 0
    v_mov_b32 v76, 0
    v_mov_b32 v77, 0
    v_mov_b32 v78, 0
    v_mov_b32 v79, 0
    v_mov_b32 v80, 0
    v_mov_b32 v81, 0
    v_mov_b32 v82, 0
    v_mov_b32 v83, 0
    v_mov_b32 v84, 0
    v_mov_b32 v85, 0
    v_mov_b32 v86, 0
    v_mov_b32 v87, 0
    v_mov_b32 v88, 0
    v_mov_b32 v89, 0
    v_mov_b32 v90, 0
    v_mov_b32 v91, 0
    v_mov_b32 v92, 0
    v_mov_b32 v93, 0
    v_mov_b32 v94, 0
    v_mov_b32 v95, 0
    s_and_b32 s48, s3, 1
    s_bfe_u32 s49, s3, 0x10001
    v_lshrrev_b32 v8, 5, v4
    v_bfe_u32 v160, v4, 2, 2
    v_lshl_add_u32 v160, v8, 2, v160
    v_lshlrev_b32 v160, 7, v160
    v_bfe_u32 v9, v4, 3, 1
    v_lshl_add_u32 v160, v9, 6, v160
    v_and_b32 v9, 1, v4
    v_lshl_add_u32 v160, v9, 5, v160
    v_bfe_u32 v9, v4, 4, 1
    v_lshl_add_u32 v160, v9, 4, v160
    v_bfe_u32 v9, v4, 1, 1
    v_lshl_add_u32 v160, v9, 3, v160
    s_lshl_b32 s26, s49, 14
    v_add_u32 v161, s26, v160
    s_lshl_b32 s26, s49, 6
    v_xor_b32 v161, s26, v161
    v_xor_b32 v160, 64, v161
    v_and_b32 v162, 31, v4
    v_lshlrev_b32 v162, 11, v162
    v_lshl_add_u32 v162, v8, 5, v162
    s_lshl_b32 s26, s4, 17
    s_lshl_b32 s50, s48, 16
    s_add_u32 s26, s26, s50
    s_lshl_b32 s27, s5, 7
    s_add_u32 s26, s26, s27
    s_lshl_b32 s50, s49, 6
    s_add_u32 s50, s50, s26
    s_add_u32 s50, s50, 1024
    s_lshl_b32 s51, s49, 2
    s_add_u32 s51, s51, s5
    v_and_b32 v163, 3, v4
    v_add_u32 v163, s51, v163
    v_and_b32 v163, 7, v163
    v_lshlrev_b32 v163, 7, v163
    s_lshl_b32 s52, s4, 10
    s_add_u32 s52, s52, 12615680
    s_lshl_b32 s53, s4, 16
    s_lshl_b32 s26, s48, 15
    s_add_u32 s53, s53, s26
    s_add_u32 s53, s53, 6291456
    s_sub_u32 s26, s3, 4
    s_lshl_b32 s27, s26, 12
    s_add_u32 s27, s27, 98304
    v_add_u32 v164, s27, v5
    v_xor_b32 v165, 0x2000, v164
    s_lshl_b32 s26, s26, 2
    v_add_u32 v166, s26, v12
    v_xor_b32 v167, 8, v166
    s_lshl_b32 s54, s4, 1
    s_add_u32 s54, s54, s24
    s_lshl_b32 s54, s54, 15
    s_lshl_b32 s26, s18, 10
    s_add_u32 s54, s54, s26
    s_add_u32 s54, s54, 6291456
    v_mov_b32 v8, -1
    v_mov_b32 v9, -1
    v_mov_b32 v10, -1
    v_mov_b32 v11, -1
    s_lshl_b32 s55, s4, 3
    s_add_u32 s55, s55, s5
    s_lshl_b32 s55, s55, 7
    s_add_u32 s55, s55, 12615680
    buffer_store_dwordx4 v[8:11], v5, s[8:11], s54 offen sc1
    s_waitcnt vmcnt(9)
    s_barrier
    s_mov_b32 m0, s59
    s_nop 0
    buffer_load_dwordx4 v16, s[60:63], s58 offen lds
    buffer_load_dwordx4 v17, s[60:63], s58 offen offset:1024 lds
    s_waitcnt vmcnt(7)
    s_barrier
    s_waitcnt vmcnt(3)
    s_barrier
    s_load_dwordx2 s[32:33], s[0:1], 88
    s_waitcnt lgkmcnt(0)
    s_barrier
    ds_read_b32 v1, v12 offset:0
    s_waitcnt lgkmcnt(0)
    v_readfirstlane_b32 s7, v1
    s_waitcnt vmcnt(0)
    v_mov_b32 v3, 1
    s_mov_b64 exec, 1
    ds_add_u32 v12, v3 offset:92
    s_mov_b64 exec, -1
    s_branch L_att
L_gen2:
    s_mov_b32 s8, s38
    s_mov_b32 s9, s39
    s_mov_b32 s10, 0x2000000
    s_mov_b32 s11, 0x00020000
    s_mov_b32 s12, s36
    s_mov_b32 s13, s37
    s_mov_b32 s14, 0x100
    s_mov_b32 s15, 0x00020000
    v_mov_b32 v18, 0
    s_or_b32 s46, s2, s3
    s_cmp_eq_u32 s46, 0
    s_cbranch_scc0 L_notag
    s_memrealtime s[46:47]
    s_waitcnt lgkmcnt(0)
    s_or_b32 s46, s46, 1
    v_mov_b32 v1, s46
    s_mov_b64 exec, 1
    buffer_store_dword v1, v18, s[12:15], 0 offen sc1
    s_mov_b64 exec, -1
    s_waitcnt vmcnt(0)
L_notag:
    s_lshl_b32 s62, s3, 14
    s_add_u32 s62, s62, 98304
    v_and_b32 v10, 7, v4
    v_lshlrev_b32 v10, 4, v10
    v_lshl_add_u32 v13, v4, 7, v10
    v_add_u32 v13, s62, v13
    v_lshrrev_b32 v10, 5, v4
    v_bfe_u32 v11, v4, 3, 1
    v_lshl_add_u32 v10, v10, 2, v11
    v_bfe_u32 v11, v4, 2, 1
    v_lshlrev_b32 v11, 2, v11
    v_bfe_u32 v12, v4, 4, 1
    v_lshl_add_u32 v11, v12, 1, v11
    v_bfe_u32 v12, v4, 1, 1
    v_add_u32 v11, v11, v12
    v_xor_b32 v11, v11, v10
    v_lshlrev_b32 v11, 4, v11
    v_lshl_add_u32 v11, v10, 7, v11
    v_and_b32 v12, 1, v4
    v_lshl_add_u32 v11, v12, 3, v11
    v_add_u32 v14, s62, v11
    v_xor_b32 v15, 32, v14
    v_add_u32 v15, 256, v15
    v_lshl_add_u32 v16, v4, 4, s62
    v_xor_b32 v17, 0x4000, v16
    v_mov_b32 v12, 94208
    s_mov_b32 s51, 0x3fb8aa3b
    s_load_dwordx4 s[32:35], s[0:1], 88
    s_waitcnt vmcnt(1) lgkmcnt(0)
    v_lshlrev_b32 v20, 16, v20
    v_lshlrev_b32 v21, 16, v21
    v_lshlrev_b32 v22, 16, v22
    v_lshlrev_b32 v23, 16, v23
    v_lshlrev_b32 v24, 16, v24
    v_lshlrev_b32 v25, 16, v25
    v_lshlrev_b32 v26, 16, v26
    v_lshlrev_b32 v27, 16, v27
    v_mul_f32 v26, s51, v26
    v_exp_f32 v26, v26
    s_nop 0
    v_cvt_pk_bf16_f32 v26, v26, v26
    v_lshlrev_b32 v26, 16, v26
    v_mul_f32 v20, v26, v20
    v_mul_f32 v21, v26, v21
    v_mul_f32 v22, v26, v22
    v_mul_f32 v23, v26, v23
    v_mul_f32 v20, s51, v20
    v_mul_f32 v21, 0.15915494, v21
    v_mul_f32 v96, v24, v22
    v_mul_f32 v97, v25, v22
    v_fma_f32 v96, -v25, v23, v96
    v_fmac_f32 v97, v24, v23
    v_mul_f32 v136, 0x3f800000, v20
    v_mul_f32 v137, 0x3f800000, v21
    v_mul_f32 v138, 0x41000000, v20
    v_mul_f32 v139, 0x41000000, v21
    v_mul_f32 v140, 0x42000000, v20
    v_mul_f32 v141, 0x42000000, v21
    v_mul_f32 v142, 0x43800000, v20
    v_mul_f32 v143, 0x43800000, v21
    v_mul_f32 v144, 0x44800000, v20
    v_mul_f32 v145, 0x44800000, v21
    v_exp_f32 v136, v136
    v_fract_f32 v137, v137
    v_exp_f32 v138, v138
    v_fract_f32 v139, v139
    v_exp_f32 v140, v140
    v_fract_f32 v141, v141
    v_exp_f32 v142, v142
    v_fract_f32 v143, v143
    v_exp_f32 v144, v144
    v_fract_f32 v145, v145
    v_cos_f32 v114, v137
    v_sin_f32 v115, v137
    v_cos_f32 v34, v139
    v_sin_f32 v35, v139
    v_cos_f32 v120, v141
    v_sin_f32 v121, v141
    v_cos_f32 v122, v143
    v_sin_f32 v123, v143
    v_cos_f32 v128, v145
    v_sin_f32 v129, v145
    v_mov_b32 v32, 1.0
    v_mov_b32 v33, 0
    v_mul_f32 v114, v114, v136
    v_mul_f32 v115, v115, v136
    v_mul_f32 v34, v34, v138
    v_mul_f32 v35, v35, v138
    v_mul_f32 v120, v120, v140
    v_mul_f32 v121, v121, v140
    v_mul_f32 v122, v122, v142
    v_mul_f32 v123, v123, v142
    v_mul_f32 v128, v128, v144
    v_mul_f32 v129, v129, v144
    v_mul_f32 v36, v34, v34
    v_mul_f32 v37, v35, v34
    v_mul_f32 v116, v114, v114
    v_mul_f32 v117, v115, v114
    v_mul_f32 v98, v96, v114
    v_mul_f32 v99, v97, v114
    v_mul_f32 v112, v96, v34
    v_mul_f32 v113, v97, v34
    v_mul_f32 v124, v122, v122
    v_mul_f32 v125, v123, v122
    v_mul_f32 v130, v128, v122
    v_mul_f32 v131, v129, v122
    v_mul_f32 v42, v34, v120
    v_mul_f32 v43, v35, v120
    v_fma_f32 v36, -v35, v35, v36
    v_fmac_f32 v37, v34, v35
    v_fma_f32 v116, -v115, v115, v116
    v_fmac_f32 v117, v114, v115
    v_fma_f32 v98, -v97, v115, v98
    v_fmac_f32 v99, v96, v115
    v_fma_f32 v112, -v97, v35, v112
    v_fmac_f32 v113, v96, v35
    v_fma_f32 v124, -v123, v123, v124
    v_fmac_f32 v125, v122, v123
    v_fma_f32 v130, -v129, v123, v130
    s_barrier
    v_fmac_f32 v131, v128, v123
    v_fma_f32 v42, -v35, v121, v42
    v_fmac_f32 v43, v34, v121
    v_mov_b32 v40, v120
    v_mov_b32 v41, v121
    v_mul_f32 v38, v36, v34
    v_mul_f32 v39, v37, v34
    v_mul_f32 v118, v116, v116
    v_mul_f32 v119, v117, v116
    v_mul_f32 v100, v96, v116
    v_mul_f32 v101, v97, v116
    v_mul_f32 v102, v98, v116
    v_mul_f32 v103, v99, v116
    v_mul_f32 v126, v124, v122
    v_mul_f32 v127, v125, v122
    v_mul_f32 v132, v128, v124
    v_mul_f32 v133, v129, v124
    v_mul_f32 v44, v36, v120
    v_mul_f32 v45, v37, v120
    v_fma_f32 v38, -v37, v35, v38
    v_fmac_f32 v39, v36, v35
    v_fma_f32 v118, -v117, v117, v118
    v_fmac_f32 v119, v116, v117
    v_fma_f32 v100, -v97, v117, v100
    v_fmac_f32 v101, v96, v117
    v_fma_f32 v102, -v99, v117, v102
    v_fmac_f32 v103, v98, v117
    v_fma_f32 v126, -v125, v123, v126
    v_fmac_f32 v127, v124, v123
    v_fma_f32 v132, -v129, v125, v132
    v_fmac_f32 v133, v128, v125
    v_fma_f32 v44, -v37, v121, v44
    v_fmac_f32 v45, v36, v121
    v_mul_f32 v46, v38, v120
    v_mul_f32 v47, v39, v120
    v_mul_f32 v104, v96, v118
    v_mul_f32 v105, v97, v118
    v_mul_f32 v106, v98, v118
    v_mul_f32 v107, v99, v118
    v_mul_f32 v108, v100, v118
    v_mul_f32 v109, v101, v118
    v_mul_f32 v110, v102, v118
    v_mul_f32 v111, v103, v118
    v_mul_f32 v134, v128, v126
    v_mul_f32 v135, v129, v126
    v_fma_f32 v46, -v39, v121, v46
    v_fmac_f32 v47, v38, v121
    v_fma_f32 v104, -v97, v119, v104
    v_fmac_f32 v105, v96, v119
    v_fma_f32 v106, -v99, v119, v106
    v_fmac_f32 v107, v98, v119
    v_fma_f32 v108, -v101, v119, v108
    v_fmac_f32 v109, v100, v119
    v_fma_f32 v110, -v103, v119, v110
    v_fmac_f32 v111, v102, v119
    v_fma_f32 v134, -v129, v127, v134
    v_fmac_f32 v135, v128, v127
    v_mul_f32 v48, v40, v120
    v_mul_f32 v49, v41, v120
    v_mul_f32 v50, v42, v120
    v_mul_f32 v51, v43, v120
    v_mul_f32 v52, v44, v120
    v_mul_f32 v53, v45, v120
    v_mul_f32 v54, v46, v120
    v_mul_f32 v55, v47, v120
    v_fma_f32 v48, -v41, v121, v48
    v_fmac_f32 v49, v40, v121
    v_fma_f32 v50, -v43, v121, v50
    v_fmac_f32 v51, v42, v121
    v_fma_f32 v52, -v45, v121, v52
    v_fmac_f32 v53, v44, v121
    v_fma_f32 v54, -v47, v121, v54
    v_fmac_f32 v55, v46, v121
    v_mul_f32 v56, v48, v120
    v_mul_f32 v57, v49, v120
    v_mul_f32 v58, v50, v120
    v_mul_f32 v59, v51, v120
    v_mul_f32 v60, v52, v120
    v_mul_f32 v61, v53, v120
    v_mul_f32 v62, v54, v120
    v_mul_f32 v63, v55, v120
    v_fma_f32 v56, -v49, v121, v56
    v_fmac_f32 v57, v48, v121
    v_fma_f32 v58, -v51, v121, v58
    v_fmac_f32 v59, v50, v121
    v_fma_f32 v60, -v53, v121, v60
    v_fmac_f32 v61, v52, v121
    v_fma_f32 v62, -v55, v121, v62
    v_fmac_f32 v63, v54, v121
    v_mul_f32 v64, v56, v120
    v_mul_f32 v65, v57, v120
    v_mul_f32 v66, v58, v120
    v_mul_f32 v67, v59, v120
    v_mul_f32 v68, v60, v120
    v_mul_f32 v69, v61, v120
    v_mul_f32 v70, v62, v120
    v_mul_f32 v71, v63, v120
    v_fma_f32 v64, -v57, v121, v64
    v_fmac_f32 v65, v56, v121
    v_fma_f32 v66, -v59, v121, v66
    v_fmac_f32 v67, v58, v121
    v_fma_f32 v68, -v61, v121, v68
    v_fmac_f32 v69, v60, v121
    v_fma_f32 v70, -v63, v121, v70
    v_fmac_f32 v71, v62, v121
    v_mul_f32 v72, v64, v120
    v_mul_f32 v73, v65, v120
    v_mul_f32 v74, v66, v120
    v_mul_f32 v75, v67, v120
    v_mul_f32 v76, v68, v120
    v_mul_f32 v77, v69, v120
    v_mul_f32 v78, v70, v120
    v_mul_f32 v79, v71, v120
    v_fma_f32 v72, -v65, v121, v72
    v_fmac_f32 v73, v64, v121
    v_fma_f32 v74, -v67, v121, v74
    v_fmac_f32 v75, v66, v121
    v_fma_f32 v76, -v69, v121, v76
    v_fmac_f32 v77, v68, v121
    v_fma_f32 v78, -v71, v121, v78
    v_fmac_f32 v79, v70, v121
    v_mul_f32 v80, v72, v120
    v_mul_f32 v81, v73, v120
    v_mul_f32 v82, v74, v120
    v_mul_f32 v83, v75, v120
    v_mul_f32 v84, v76, v120
    v_mul_f32 v85, v77, v120
    v_mul_f32 v86, v78, v120
    v_mul_f32 v87, v79, v120
    v_fma_f32 v80, -v73, v121, v80
    v_fmac_f32 v81, v72, v121
    v_fma_f32 v82, -v75, v121, v82
    v_fmac_f32 v83, v74, v121
    v_fma_f32 v84, -v77, v121, v84
    v_fmac_f32 v85, v76, v121
    v_fma_f32 v86, -v79, v121, v86
    v_fmac_f32 v87, v78, v121
    v_mul_f32 v88, v80, v120
    v_mul_f32 v89, v81, v120
    v_mul_f32 v90, v82, v120
    v_mul_f32 v91, v83, v120
    v_mul_f32 v92, v84, v120
    v_mul_f32 v93, v85, v120
    v_mul_f32 v94, v86, v120
    v_mul_f32 v95, v87, v120
    s_barrier
    v_fma_f32 v88, -v81, v121, v88
    v_fmac_f32 v89, v80, v121
    v_fma_f32 v90, -v83, v121, v90
    v_fmac_f32 v91, v82, v121
    v_fma_f32 v92, -v85, v121, v92
    v_fmac_f32 v93, v84, v121
    v_fma_f32 v94, -v87, v121, v94
    v_fmac_f32 v95, v86, v121
    v_cvt_pk_bf16_f32 v136, v32, v34
    v_cvt_pk_bf16_f32 v137, v36, v38
    v_cvt_pk_bf16_f32 v138, v40, v42
    v_cvt_pk_bf16_f32 v139, v44, v46
    v_cvt_pk_bf16_f32 v140, v48, v50
    v_cvt_pk_bf16_f32 v141, v52, v54
    v_cvt_pk_bf16_f32 v142, v56, v58
    v_cvt_pk_bf16_f32 v143, v60, v62
    v_cvt_pk_bf16_f32 v144, v64, v66
    v_cvt_pk_bf16_f32 v145, v68, v70
    v_cvt_pk_bf16_f32 v146, v72, v74
    v_cvt_pk_bf16_f32 v147, v76, v78
    v_cvt_pk_bf16_f32 v148, v80, v82
    v_cvt_pk_bf16_f32 v149, v84, v86
    v_cvt_pk_bf16_f32 v150, v88, v90
    v_cvt_pk_bf16_f32 v151, v92, v94
    v_cvt_pk_bf16_f32 v152, v33, v35
    v_cvt_pk_bf16_f32 v153, v37, v39
    v_cvt_pk_bf16_f32 v154, v41, v43
    v_cvt_pk_bf16_f32 v155, v45, v47
    v_cvt_pk_bf16_f32 v156, v49, v51
    v_cvt_pk_bf16_f32 v157, v53, v55
    v_cvt_pk_bf16_f32 v158, v57, v59
    v_cvt_pk_bf16_f32 v159, v61, v63
    v_cvt_pk_bf16_f32 v160, v65, v67
    v_cvt_pk_bf16_f32 v161, v69, v71
    v_cvt_pk_bf16_f32 v162, v73, v75
    v_cvt_pk_bf16_f32 v163, v77, v79
    v_cvt_pk_bf16_f32 v164, v81, v83
    v_cvt_pk_bf16_f32 v165, v85, v87
    v_cvt_pk_bf16_f32 v166, v89, v91
    v_cvt_pk_bf16_f32 v167, v93, v95
    v_mul_f32 v32, v96, v128
    v_mul_f32 v33, v97, v128
    v_mul_f32 v34, v112, v128
    v_mul_f32 v35, v113, v128
    v_mul_f32 v36, v96, v130
    v_mul_f32 v37, v97, v130
    v_mul_f32 v38, v112, v130
    v_mul_f32 v39, v113, v130
    v_mul_f32 v40, v96, v132
    v_mul_f32 v41, v97, v132
    s_barrier
    s_barrier
    s_barrier
    s_barrier
    s_barrier
    s_barrier
    buffer_load_dword v1, v18, s[12:15], 0 offen sc1
    s_barrier
    s_barrier
    s_barrier
    s_barrier
    s_barrier
    s_barrier
    s_waitcnt vmcnt(0)
    s_mov_b32 s66, 0
L_tp1:
    v_readfirstlane_b32 s7, v1
    s_add_u32 s66, s66, 1
    s_cmp_lg_u32 s7, 0
    s_cbranch_scc1 L_te2
    s_cmp_ge_u32 s66, 524288
    s_cbranch_scc1 L_te2
    buffer_load_dword v1, v18, s[12:15], 0 offen sc1
    s_waitcnt vmcnt(0)
    s_branch L_tp1
L_te2:
    v_cmp_eq_u32 vcc, 0, v4
    v_lshl_add_u32 v2, v4, 2, v12
    s_cmp_eq_u32 s3, 0
    v_cndmask_b32 v1, 0, v1, vcc
    s_cbranch_scc0 L_tagd
    ds_write_b32 v2, v1
    s_waitcnt lgkmcnt(0)
L_tagd:
    s_barrier
    v_fma_f32 v32, -v97, v129, v32
    v_fmac_f32 v33, v96, v129
    v_fma_f32 v34, -v113, v129, v34
    v_fmac_f32 v35, v112, v129
    v_fma_f32 v36, -v97, v131, v36
    v_fmac_f32 v37, v96, v131
    v_fma_f32 v38, -v113, v131, v38
    v_fmac_f32 v39, v112, v131
    v_fma_f32 v40, -v97, v133, v40
    v_fmac_f32 v41, v96, v133
    v_mul_f32 v42, v112, v132
    v_mul_f32 v43, v113, v132
    v_mul_f32 v44, v96, v122
    v_mul_f32 v45, v97, v122
    v_mul_f32 v46, v100, v122
    v_mul_f32 v47, v101, v122
    v_mul_f32 v48, v104, v122
    v_mul_f32 v49, v105, v122
    v_mul_f32 v50, v108, v122
    v_mul_f32 v51, v109, v122
    v_fma_f32 v42, -v113, v133, v42
    v_fmac_f32 v43, v112, v133
    v_fma_f32 v44, -v97, v123, v44
    v_fmac_f32 v45, v96, v123
    v_fma_f32 v46, -v101, v123, v46
    v_fmac_f32 v47, v100, v123
    v_fma_f32 v48, -v105, v123, v48
    v_fmac_f32 v49, v104, v123
    v_fma_f32 v50, -v109, v123, v50
    v_fmac_f32 v51, v108, v123
    v_mul_f32 v52, v112, v122
    v_mul_f32 v53, v113, v122
    v_mul_f32 v54, v96, v124
    v_mul_f32 v55, v97, v124
    v_mul_f32 v56, v104, v124
    v_mul_f32 v57, v105, v124
    v_mul_f32 v58, v112, v124
    v_mul_f32 v59, v113, v124
    v_mul_f32 v60, v96, v126
    v_mul_f32 v61, v97, v126
    v_fma_f32 v52, -v113, v123, v52
    v_fmac_f32 v53, v112, v123
    v_fma_f32 v54, -v97, v125, v54
    v_fmac_f32 v55, v96, v125
    v_fma_f32 v56, -v105, v125, v56
    v_fmac_f32 v57, v104, v125
    v_fma_f32 v58, -v113, v125, v58
    v_fmac_f32 v59, v112, v125
    v_fma_f32 v60, -v97, v127, v60
    v_fmac_f32 v61, v96, v127
    v_mul_f32 v62, v104, v126
    v_mul_f32 v63, v105, v126
    v_mul_f32 v64, v112, v126
    v_mul_f32 v65, v113, v126
    v_mul_f32 v66, v96, v134
    v_mul_f32 v67, v97, v134
    v_mul_f32 v68, v112, v134
    v_mul_f32 v69, v113, v134
    v_fma_f32 v62, -v105, v127, v62
    v_fmac_f32 v63, v104, v127
    v_fma_f32 v64, -v113, v127, v64
    v_fmac_f32 v65, v112, v127
    v_fma_f32 v66, -v97, v135, v66
    v_fmac_f32 v67, v96, v135
    v_fma_f32 v68, -v113, v135, v68
    v_fmac_f32 v69, v112, v135
    v_cvt_pk_bf16_f32 v70, v96, v98
    v_cvt_pk_bf16_f32 v71, v100, v102
    v_cvt_pk_bf16_f32 v72, v44, v46
    v_cvt_pk_bf16_f32 v73, v48, v50
    v_cvt_pk_bf16_f32 v74, v104, v106
    v_cvt_pk_bf16_f32 v75, v108, v110
    v_cvt_pk_bf16_f32 v76, v52, v54
    v_cvt_pk_bf16_f32 v77, v56, v58
    v_cvt_pk_bf16_f32 v78, v112, v32
    v_cvt_pk_bf16_f32 v79, v34, v36
    v_cvt_pk_bf16_f32 v80, v60, v62
    v_cvt_pk_bf16_f32 v81, v64, v66
    v_cvt_pk_bf16_f32 v82, v38, v40
    v_cvt_pk_bf16_f32 v83, v42, v96
    v_cvt_pk_bf16_f32 v84, v68, v96
    v_cvt_pk_bf16_f32 v85, v96, v96
    v_cvt_pk_bf16_f32 v86, -v97, -v99
    v_cvt_pk_bf16_f32 v87, -v101, -v103
    v_cvt_pk_bf16_f32 v88, -v45, -v47
    v_cvt_pk_bf16_f32 v89, -v49, -v51
    v_cvt_pk_bf16_f32 v90, -v105, -v107
    v_cvt_pk_bf16_f32 v91, -v109, -v111
    v_cvt_pk_bf16_f32 v92, -v53, -v55
    v_cvt_pk_bf16_f32 v93, -v57, -v59
    v_cvt_pk_bf16_f32 v114, -v113, -v33
    v_cvt_pk_bf16_f32 v115, -v35, -v37
    v_cvt_pk_bf16_f32 v116, -v61, -v63
    v_cvt_pk_bf16_f32 v117, -v65, -v67
    v_cvt_pk_bf16_f32 v118, -v39, -v41
    v_cvt_pk_bf16_f32 v119, -v43, -v97
    v_cvt_pk_bf16_f32 v120, -v69, -v97
    v_cvt_pk_bf16_f32 v121, -v97, -v97
    v_xor_b32 v32, 0, v13
    v_xor_b32 v33, 16, v13
    v_xor_b32 v34, 32, v13
    v_xor_b32 v35, 48, v13
    v_xor_b32 v36, 64, v13
    v_xor_b32 v37, 80, v13
    v_xor_b32 v38, 96, v13
    v_xor_b32 v39, 112, v13
    v_lshrrev_b32 v9, 4, v4
    v_bfe_u32 v10, v4, 2, 2
    v_lshl_add_u32 v10, v9, 3, v10
    v_lshlrev_b32 v5, 7, v10
    v_and_b32 v10, 3, v4
    v_lshl_add_u32 v5, v10, 3, v5
    s_lshl_b32 s66, s3, 5
    s_add_u32 s66, s66, 74752
    v_add_u32 v5, s66, v5
    v_and_b32 v10, 7, v4
    v_xor_b32 v9, v9, v10
    v_lshlrev_b32 v9, 4, v9
    v_and_b32 v10, 15, v4
    v_lshl_add_u32 v6, v10, 7, v9
    s_lshl_b32 s66, s3, 11
    s_add_u32 s66, s66, 82944
    v_add_u32 v6, s66, v6
    v_lshl_add_u32 v7, v4, 4, s66
    v_lshrrev_b32 v9, 3, v4
    s_barrier
    v_and_b32 v10, 7, v4
    v_xor_b32 v10, v10, v9
    v_mul_u32_u24 v122, 4224, v9
    v_lshl_add_u32 v8, v10, 4, v122
    v_and_b32 v11, 7, v4
    v_lshl_add_u32 v122, v11, 4, v122
    v_add_u32 v123, 32768, v122
    v_and_b32 v124, 1, v9
    v_lshrrev_b32 v125, 1, v9
    v_lshl_add_u32 v124, v124, 5, v125
    v_lshlrev_b32 v124, 11, v124
    v_lshl_add_u32 v124, v10, 4, v124
    v_bfe_u32 v10, v4, 4, 1
    v_lshlrev_b32 v10, 2, v10
    v_xor_b32 v10, v10, v11
    v_lshlrev_b32 v125, 10, v9
    v_lshl_add_u32 v125, v10, 4, v125
    v_and_b32 v28, 31, v4
    v_lshrrev_b32 v29, 5, v4
    v_lshlrev_b32 v126, 6, v28
    v_lshlrev_b32 v127, 6, v4
    v_lshlrev_b32 v128, 2, v28
    v_lshl_add_u32 v128, v29, 8, v128
    v_and_b32 v129, 15, v4
    v_lshlrev_b32 v129, 10, v129
    s_lshl_b32 s63, s61, 2
    v_add_u32 v11, s63, v12
    s_lshl_b32 s64, s61, 15
    s_add_u32 s64, s64, 107520
    s_lshl_b32 s46, s53, 6
    s_add_u32 s46, s46, s62
    s_add_u32 s46, s46, 8176
    v_lshlrev_b32 v10, 4, v28
    v_sub_u32 v9, s46, v10
    v_cmp_eq_u32 s[56:57], 0, v4
    v_mul_i32_i24 v10, 512, v29
    v_sub_u32 v96, v9, v10
    v_mul_i32_i24 v10, -1024, v29
    v_sub_u32 v97, v9, v10
    v_subrev_u32 v97, 2048, v97
    v_subrev_u32 v98, 1536, v9
    v_lshrrev_b32 v10, 2, v28
    v_lshlrev_b32 v10, 1, v10
    v_lshl_add_u32 v10, v29, 5, v10
    s_lshl_b32 s47, s53, 1
    s_sub_u32 s47, s46, s47
    s_add_u32 s48, s47, -3410
    v_sub_u32 v10, s48, v10
    v_and_b32 v99, 3, v28
    v_lshl_add_u32 v99, v99, 7, v10
    v_bfe_u32 v100, v28, 1, 1
    v_lshl_add_u32 v100, v100, 7, v10
    s_add_u32 s48, s46, -3664
    v_lshl_add_u32 v101, v4, 4, s48
    s_add_u32 s48, s47, -3590
    v_lshl_add_u32 v102, v4, 1, s48
    s_add_u32 s48, s46, 16
    v_lshl_add_u32 v103, v4, 4, s48
    s_lshl_b32 s47, s53, 1
    v_add_u32 v10, s47, v29
    v_mul_u32_u24 v10, 1536, v10
    v_lshl_add_u32 v10, v28, 4, v10
    v_add_u32 v104, s64, v10
    v_and_b32 v9, 30, v4
    v_and_b32 v10, 1, v4
    v_lshlrev_b32 v24, 3, v29
    v_sub_u32 v24, v24, v9
    v_lshlrev_b32 v24, 1, v24
    v_mul_u32_u24 v9, 16444, v10
    v_add_u32 v24, v24, v9
    s_add_u32 s46, s64, -1216
    v_add_u32 v24, s46, v24
    s_lshl_b32 s46, s53, 9
    s_add_u32 s46, s46, s64
    s_add_u32 s46, s46, 464
    v_mul_u32_u24 v25, 1536, v29
    v_lshl_add_u32 v25, v28, 4, v25
    v_add_u32 v25, s46, v25
    v_lshlrev_b32 v20, 1, v28
    v_lshl_add_u32 v20, v29, 8, v20
    s_add_u32 s46, s62, 64
    v_add_u32 v20, s46, v20
    v_xor_b32 v10, 1, v10
    v_mul_u32_u24 v21, 16446, v10
    v_lshlrev_b32 v10, 3, v29
    v_sub_u32 v10, v10, v28
    v_lshl_add_u32 v21, v10, 1, v21
    s_add_u32 s46, s62, 4798
    v_add_u32 v21, s46, v21
    v_bfe_u32 v9, v4, 2, 2
    v_lshl_add_u32 v9, v29, 3, v9
    v_bfe_u32 v10, v4, 4, 1
    v_lshlrev_b32 v10, 2, v10
    v_and_b32 v30, 3, v4
    v_add_u32 v10, v10, v30
    v_lshlrev_b32 v22, 6, v9
    v_lshl_add_u32 v22, v10, 3, v22
    s_add_u32 s46, s62, 16
    v_add_u32 v22, s46, v22
    s_add_u32 s46, s64, 496
    v_add_u32 v30, 7, v10
    v_and_b32 v19, 1, v30
    v_lshlrev_b32 v23, 3, v19
    v_bfe_u32 v19, v30, 1, 2
    v_mul_u32_u24 v19, 1536, v19
    v_add_u32 v23, v23, v19
    v_lshrrev_b32 v30, 3, v30
    v_add_u32 v30, v30, v9
    v_lshl_add_u32 v23, v30, 4, v23
    v_add_u32 v23, s46, v23
    v_add_u32 v30, 3, v10
    v_and_b32 v19, 1, v30
    v_lshlrev_b32 v26, 3, v19
    v_bfe_u32 v19, v30, 1, 2
    v_mul_u32_u24 v19, 1536, v19
    v_add_u32 v26, v26, v19
    v_lshrrev_b32 v30, 3, v30
    v_add_u32 v30, v30, v9
    v_lshl_add_u32 v26, v30, 4, v26
    v_add_u32 v26, s46, v26
    s_barrier
    s_setprio 3
    s_mov_b32 s16, s34
    s_mov_b32 s17, s35
    s_mov_b32 s18, 0x400000
    s_mov_b32 s19, 0x00020000
    s_mov_b32 s12, s32
    s_mov_b32 s13, s33
    s_mov_b32 s14, 0x80000
    s_mov_b32 s15, 0x00020000
    ds_write_b128 v32, v[136:139]
    ds_write_b128 v32, v[70:73] offset:8192
    ds_write_b128 v33, v[140:143]
    ds_write_b128 v33, v[74:77] offset:8192
    ds_write_b128 v34, v[144:147]
    ds_write_b128 v34, v[78:81] offset:8192
    ds_write_b128 v35, v[148:151]
    ds_write_b128 v35, v[82:85] offset:8192
    ds_write_b128 v36, v[152:155]
    ds_write_b128 v36, v[86:89] offset:8192
    ds_write_b128 v37, v[156:159]
    ds_write_b128 v37, v[90:93] offset:8192
    ds_write_b128 v38, v[160:163]
    ds_write_b128 v38, v[114:117] offset:8192
    ds_write_b128 v39, v[164:167]
    ds_write_b128 v39, v[118:121] offset:8192
    s_waitcnt lgkmcnt(0)
    ds_read_b64_tr_b16 v[48:49], v14 offset:8192
    ds_read_b64_tr_b16 v[50:51], v15 offset:8192
    ds_read_b64_tr_b16 v[52:53], v14 offset:0
    ds_read_b64_tr_b16 v[54:55], v15 offset:0
    ds_read_b64_tr_b16 v[56:57], v14 offset:9216
    ds_read_b64_tr_b16 v[58:59], v15 offset:9216
    ds_read_b64_tr_b16 v[60:61], v14 offset:1024
    ds_read_b64_tr_b16 v[62:63], v15 offset:1024
    ds_read_b64_tr_b16 v[64:65], v14 offset:10240
    ds_read_b64_tr_b16 v[66:67], v15 offset:10240
    ds_read_b64_tr_b16 v[68:69], v14 offset:2048
    ds_read_b64_tr_b16 v[70:71], v15 offset:2048
    ds_read_b64_tr_b16 v[72:73], v14 offset:11264
    ds_read_b64_tr_b16 v[74:75], v15 offset:11264
    ds_read_b64_tr_b16 v[76:77], v14 offset:3072
    ds_read_b64_tr_b16 v[78:79], v15 offset:3072
    s_waitcnt lgkmcnt(12)
    v_mfma_f32_32x32x16_bf16 v[32:47], v[48:51], v[52:55], 0
    ds_read_b64_tr_b16 v[48:49], v14 offset:12288
    ds_read_b64_tr_b16 v[50:51], v15 offset:12288
    ds_read_b64_tr_b16 v[52:53], v14 offset:4096
    ds_read_b64_tr_b16 v[54:55], v15 offset:4096
    s_waitcnt lgkmcnt(12)
    v_mfma_f32_32x32x16_bf16 v[32:47], v[56:59], v[60:63], v[32:47]
    ds_read_b64_tr_b16 v[56:57], v14 offset:13312
    ds_read_b64_tr_b16 v[58:59], v15 offset:13312
    ds_read_b64_tr_b16 v[60:61], v14 offset:5120
    ds_read_b64_tr_b16 v[62:63], v15 offset:5120
    s_waitcnt lgkmcnt(12)
    v_mfma_f32_32x32x16_bf16 v[32:47], v[64:67], v[68:71], v[32:47]
    ds_read_b64_tr_b16 v[64:65], v14 offset:14336
    ds_read_b64_tr_b16 v[66:67], v15 offset:14336
    ds_read_b64_tr_b16 v[68:69], v14 offset:6144
    ds_read_b64_tr_b16 v[70:71], v15 offset:6144
    s_waitcnt lgkmcnt(12)
    v_mfma_f32_32x32x16_bf16 v[32:47], v[72:75], v[76:79], v[32:47]
    ds_read_b64_tr_b16 v[72:73], v14 offset:15360
    ds_read_b64_tr_b16 v[74:75], v15 offset:15360
    ds_read_b64_tr_b16 v[76:77], v14 offset:7168
    ds_read_b64_tr_b16 v[78:79], v15 offset:7168
    s_waitcnt lgkmcnt(12)
    v_mfma_f32_32x32x16_bf16 v[32:47], v[48:51], v[52:55], v[32:47]
    s_waitcnt lgkmcnt(8)
    v_mfma_f32_32x32x16_bf16 v[32:47], v[56:59], v[60:63], v[32:47]
    s_waitcnt lgkmcnt(4)
    v_mfma_f32_32x32x16_bf16 v[32:47], v[64:67], v[68:71], v[32:47]
    s_waitcnt lgkmcnt(0)
    v_mfma_f32_32x32x16_bf16 v[32:47], v[72:75], v[76:79], v[32:47]
    s_nop 15
    ds_write_b128 v16, v[32:35] offset:0
    ds_write_b128 v16, v[36:39] offset:1024
    ds_write_b128 v16, v[40:43] offset:2048
    ds_write_b128 v16, v[44:47] offset:3072
    s_waitcnt lgkmcnt(0)
    v_mov_b32 v1, 1
    s_mov_b64 exec, 1
    ds_add_u32 v11, v1 offset:80
    s_mov_b64 exec, -1
    s_mov_b32 s66, 0
L_sp3:
    ds_read_b32 v3, v12 offset:92
    s_add_u32 s66, s66, 1
    s_waitcnt lgkmcnt(0)
    v_readfirstlane_b32 s67, v3
    s_cmp_ge_u32 s66, 524288
    s_cbranch_scc1 L_se4
    s_cmp_ge_u32 s67, 4
    s_cbranch_scc1 L_se4
    s_sleep 1
    s_branch L_sp3
L_se4:
    ds_read_b64_tr_b16 v[48:49], v5
    ds_read_b64_tr_b16 v[50:51], v5 offset:512
    ds_read_b64_tr_b16 v[52:53], v5 offset:4096
    ds_read_b64_tr_b16 v[54:55], v5 offset:4608
    v_xor_b32 v10, 64, v6
    s_waitcnt lgkmcnt(2)
    ds_write_b128 v6, v[48:51]
    s_waitcnt lgkmcnt(1)
    ds_write_b128 v10, v[52:55]
    s_waitcnt lgkmcnt(0)
    ds_read_b128 v[80:83], v7
    ds_read_b128 v[84:87], v7 offset:1024
    s_mul_i32 s46, s44, 270336
    s_mul_i32 s47, s3, 67584
    s_add_u32 s46, s46, s47
    s_lshl_b32 s47, s45, 7
    s_add_u32 s46, s46, s47
    s_add_u32 s46, s46, 8388608
    s_add_u32 s47, s46, 33792
    s_lshl_b32 s65, s44, 5
    s_add_u32 s65, s65, s45
    s_lshl_b32 s65, s65, 6
    s_add_u32 s65, s65, 12599296
    s_mov_b32 s58, -1
    s_mov_b32 s59, 0
    s_mov_b32 s40, 0
    s_mov_b32 s41, -1
    s_mov_b32 s42, 0x55555555
    s_mov_b32 s43, 0x55555555
    v_mov_b32 v88, 0
    v_mov_b32 v89, 0
    v_mov_b32 v90, 0
    v_mov_b32 v91, 0
    s_waitcnt lgkmcnt(1)
    buffer_store_dwordx4 v[80:83], v8, s[8:11], s46 offen sc1
    s_waitcnt lgkmcnt(0)
    buffer_store_dwordx4 v[84:87], v8, s[8:11], s47 offen sc1
    s_mov_b32 s66, 0
L_sp5:
    ds_read_b32 v1, v11 offset:80
    s_add_u32 s66, s66, 1
    s_waitcnt lgkmcnt(0)
    v_readfirstlane_b32 s67, v1
    s_cmp_ge_u32 s66, 524288
    s_cbranch_scc1 L_se6
    s_cmp_ge_u32 s67, 2
    s_cbranch_scc1 L_se6
    s_sleep 1
    s_branch L_sp5
L_se6:
    ds_write_b128 v104, v[88:91]
    ds_write_b128 v101, v[88:91]
    ds_read_b128 v[48:51], v17 offset:0
    ds_read_b128 v[52:55], v17 offset:1024
    ds_read_b128 v[56:59], v17 offset:2048
    ds_read_b128 v[60:63], v17 offset:3072
    v_mov_b32 v19, 0x3f80
    s_mov_b64 exec, 0xff
    ds_write_b16 v102, v19
    s_mov_b64 exec, -1
    v_cndmask_b32 v9, 0, v27, s[56:57]
    v_add_f32 v32, v32, v9
    s_waitcnt lgkmcnt(0)
    v_add_f32 v32, v32, v48
    v_add_f32 v33, v33, v49
    v_add_f32 v34, v34, v50
    v_add_f32 v35, v35, v51
    v_add_f32 v36, v36, v52
    v_add_f32 v37, v37, v53
    v_add_f32 v38, v38, v54
    v_add_f32 v39, v39, v55
    v_add_f32 v40, v40, v56
    v_add_f32 v41, v41, v57
    v_add_f32 v42, v42, v58
    v_add_f32 v43, v43, v59
    v_add_f32 v44, v44, v60
    v_add_f32 v45, v45, v61
    v_add_f32 v46, v46, v62
    v_add_f32 v47, v47, v63
    v_sub_f32 v48, v41, v42
    v_sub_f32 v49, v43, v44
    v_sub_f32 v50, v45, v46
    v_cvt_pk_bf16_f32 v48, v42, v48
    v_cvt_pk_bf16_f32 v49, v44, v49
    v_cvt_pk_bf16_f32 v50, v46, v50
    v_cndmask_b32 v51, 0, v41, s[56:57]
    ds_write_b16 v99, v49 offset:16
    s_mov_b64 exec, s[58:59]
    ds_write_b16 v99, v48 offset:32
    ds_write_b16 v99, v50 offset:0
    s_mov_b64 exec, s[42:43]
    ds_write_b16_d16_hi v100, v49 offset:528
    s_mov_b32 exec_hi, 0
    ds_write_b16_d16_hi v100, v48 offset:544
    ds_write_b16_d16_hi v100, v50 offset:512
    s_mov_b64 exec, -1
    s_cmp_eq_u32 s53, 0
    s_cbranch_scc0 L_copy1
    s_mov_b64 exec, s[58:59]
    v_cvt_pk_bf16_f32 v64, v40, v39
    v_cvt_pk_bf16_f32 v65, v38, v37
    v_cvt_pk_bf16_f32 v66, v36, v35
    v_cvt_pk_bf16_f32 v67, v34, v33
    v_cvt_pk_bf16_f32 v68, v89, v89
    v_cvt_pk_bf16_f32 v69, v89, v89
    v_cvt_pk_bf16_f32 v70, v89, v51
    v_cvt_pk_bf16_f32 v71, v51, v51
    s_mov_b64 exec, s[40:41]
    v_cvt_pk_bf16_f32 v64, v36, v36
    v_cvt_pk_bf16_f32 v65, v35, v34
    v_cvt_pk_bf16_f32 v66, v34, v34
    v_cvt_pk_bf16_f32 v67, v33, v32
    v_cvt_pk_bf16_f32 v68, v39, v39
    v_cvt_pk_bf16_f32 v69, v39, v38
    v_cvt_pk_bf16_f32 v70, v38, v38
    v_cvt_pk_bf16_f32 v71, v37, v37
    v_cvt_pk_bf16_f32 v72, v42, v42
    v_cvt_pk_bf16_f32 v73, v42, v41
    v_cvt_pk_bf16_f32 v74, v41, v41
    v_cvt_pk_bf16_f32 v75, v40, v40
    s_mov_b64 exec, -1
    v_cvt_pk_bf16_f32 v10, v32, v88
    v_cndmask_b32 v88, 0, v10, s[56:57]
    s_branch L_copyd
L_copy1:
    s_mov_b64 exec, s[58:59]
    v_cvt_pk_bf16_f32 v64, v39, v38
    v_cvt_pk_bf16_f32 v65, v37, v36
    v_cvt_pk_bf16_f32 v66, v35, v34
    v_cvt_pk_bf16_f32 v67, v33, v32
    v_cvt_pk_bf16_f32 v68, v89, v89
    v_cvt_pk_bf16_f32 v69, v89, v89
    v_cvt_pk_bf16_f32 v70, v51, v51
    v_cvt_pk_bf16_f32 v71, v51, v51
    s_mov_b64 exec, s[40:41]
    v_cvt_pk_bf16_f32 v64, v36, v35
    v_cvt_pk_bf16_f32 v65, v34, v34
    v_cvt_pk_bf16_f32 v66, v34, v33
    v_cvt_pk_bf16_f32 v67, v32, v32
    v_cvt_pk_bf16_f32 v68, v39, v39
    v_cvt_pk_bf16_f32 v69, v38, v38
    v_cvt_pk_bf16_f32 v70, v38, v37
    v_cvt_pk_bf16_f32 v71, v37, v37
    v_cvt_pk_bf16_f32 v72, v42, v42
    v_cvt_pk_bf16_f32 v73, v41, v41
    v_cvt_pk_bf16_f32 v74, v41, v40
    v_cvt_pk_bf16_f32 v75, v40, v40
    s_mov_b64 exec, -1
L_copyd:
    ds_write_b128 v96, v[64:67]
    ds_write_b128 v97, v[68:71]
    s_mov_b64 exec, s[40:41]
    ds_write_b128 v98, v[72:75]
    s_mov_b64 exec, 15
    ds_write_b128 v103, v[88:91]
    s_mov_b64 exec, -1
    s_waitcnt vmcnt(0)
    v_mov_b32 v1, 1
    s_mov_b64 exec, 1
    ds_add_rtn_u32 v1, v12, v1 offset:12
    v_mov_b32 v2, 0
    s_waitcnt lgkmcnt(0)
    v_readfirstlane_b32 s66, v1
    v_mov_b32 v1, s7
    s_cmp_eq_u32 s66, 3
    s_cbranch_scc0 L_np7
    buffer_store_dword v1, v2, s[8:11], s65 offen sc1
L_np7:
    s_mov_b64 exec, -1
    s_lshl_b32 s46, s44, 11
    s_add_u32 s46, s46, 12599296
    s_cmp_eq_u32 s3, 0
    s_cbranch_scc0 L_uw
    s_mov_b32 s66, 0
L_fp8:
    s_sleep 24
L_ft10:
    buffer_load_dword v1, v126, s[8:11], s46 offen sc1
    s_add_u32 s66, s66, 1
    s_waitcnt vmcnt(0)
    v_cmp_eq_u32 vcc, s7, v1
    s_cmp_ge_u32 s66, 524288
    s_cbranch_scc1 L_fe9
    s_cmp_eq_u64 vcc, -1
    s_cbranch_scc0 L_fp8
L_fe9:
    v_mov_b32 v3, 1
    s_mov_b64 exec, 1
    ds_add_u32 v12, v3 offset:36
    s_mov_b64 exec, -1
L_uw:
    s_mov_b32 s66, 0
L_sp11:
    ds_read_b32 v3, v12 offset:36
    s_add_u32 s66, s66, 1
    s_waitcnt lgkmcnt(0)
    v_readfirstlane_b32 s67, v3
    s_cmp_ge_u32 s66, 524288
    s_cbranch_scc1 L_se12
    s_cmp_ge_u32 s67, 1
    s_cbranch_scc1 L_se12
    s_sleep 4
    s_branch L_sp11
L_se12:
    s_mul_i32 s46, s52, 4224
    s_lshl_b32 s47, s53, 5
    s_add_u32 s46, s46, s47
    s_add_u32 s46, s46, 8388608
    s_mul_i32 s47, s53, 3072
    s_add_u32 s47, s47, s64
    s_add_u32 m0, s47, 512
    s_nop 0
    buffer_load_dwordx4 v127, s[8:11], s46 offen sc1 lds
    s_add_u32 m0, s47, 2048
    s_add_u32 s46, s46, 16
    buffer_load_dwordx4 v127, s[8:11], s46 offen sc1 lds
    v_mov_b32 v48, 0
    v_mov_b32 v49, 0
    v_mov_b32 v50, 0
    v_mov_b32 v51, 0
    v_mov_b32 v52, 0
    v_mov_b32 v53, 0
    v_mov_b32 v54, 0
    v_mov_b32 v55, 0
    v_mov_b32 v56, 0
    v_mov_b32 v57, 0
    v_mov_b32 v58, 0
    v_mov_b32 v59, 0
    v_mov_b32 v60, 0
    v_mov_b32 v61, 0
    v_mov_b32 v62, 0
    v_mov_b32 v63, 0
    s_add_u32 s34, s53, 8
    s_mov_b32 s35, 0
    s_waitcnt vmcnt(0) lgkmcnt(0)
    v_mov_b32 v1, 1
    s_mov_b64 exec, 1
    ds_add_u32 v12, v1 offset:24
    s_mov_b64 exec, -1
    s_and_b32 s46, s45, 7
    s_lshl_b32 s46, s46, 16
    s_lshl_b32 s47, s5, 7
    s_add_u32 s46, s46, s47
    s_lshl_b32 s47, s3, 14
    s_add_u32 s46, s46, s47
    buffer_load_dword v31, v129, s[12:15], s46 offen
    s_mov_b32 s66, 0
L_sp13:
    ds_read_b32 v1, v12 offset:24
    s_add_u32 s66, s66, 1
    s_waitcnt lgkmcnt(0)
    v_readfirstlane_b32 s67, v1
    s_cmp_ge_u32 s66, 524288
    s_cbranch_scc1 L_se14
    s_cmp_ge_u32 s67, 4
    s_cbranch_scc1 L_se14
    s_sleep 1
    s_branch L_sp13
L_se14:
L_cl:
    ds_read2_b32 v[32:33], v24 offset0:56 offset1:57
    ds_read2_b32 v[34:35], v24 offset0:58 offset1:59
    ds_read_b128 v[40:43], v25 offset:3120
    s_waitcnt lgkmcnt(0)
    v_mfma_f32_32x32x16_bf16 v[48:63], v[40:43], v[32:35], v[48:63]
    ds_read2_b32 v[36:37], v24 offset0:48 offset1:49
    ds_read2_b32 v[38:39], v24 offset0:50 offset1:51
    ds_read_b128 v[44:47], v25 offset:48
    s_waitcnt lgkmcnt(0)
    v_mfma_f32_32x32x16_bf16 v[48:63], v[44:47], v[36:39], v[48:63]
    ds_read2_b32 v[32:33], v24 offset0:40 offset1:41
    ds_read2_b32 v[34:35], v24 offset0:42 offset1:43
    ds_read_b128 v[40:43], v25 offset:3104
    s_waitcnt lgkmcnt(0)
    v_mfma_f32_32x32x16_bf16 v[48:63], v[40:43], v[32:35], v[48:63]
    ds_read2_b32 v[36:37], v24 offset0:32 offset1:33
    ds_read2_b32 v[38:39], v24 offset0:34 offset1:35
    ds_read_b128 v[44:47], v25 offset:32
    s_waitcnt lgkmcnt(0)
    v_mfma_f32_32x32x16_bf16 v[48:63], v[44:47], v[36:39], v[48:63]
    ds_read2_b32 v[32:33], v24 offset0:24 offset1:25
    ds_read2_b32 v[34:35], v24 offset0:26 offset1:27
    ds_read_b128 v[40:43], v25 offset:3088
    s_waitcnt lgkmcnt(0)
    v_mfma_f32_32x32x16_bf16 v[48:63], v[40:43], v[32:35], v[48:63]
    ds_read2_b32 v[36:37], v24 offset0:16 offset1:17
    ds_read2_b32 v[38:39], v24 offset0:18 offset1:19
    ds_read_b128 v[44:47], v25 offset:16
    s_waitcnt lgkmcnt(0)
    v_mfma_f32_32x32x16_bf16 v[48:63], v[44:47], v[36:39], v[48:63]
    ds_read2_b32 v[32:33], v24 offset0:8 offset1:9
    ds_read2_b32 v[34:35], v24 offset0:10 offset1:11
    ds_read_b128 v[40:43], v25 offset:3072
    s_waitcnt lgkmcnt(0)
    v_mfma_f32_32x32x16_bf16 v[48:63], v[40:43], v[32:35], v[48:63]
    ds_read2_b32 v[36:37], v24 offset0:0 offset1:1
    ds_read2_b32 v[38:39], v24 offset0:2 offset1:3
    ds_read_b128 v[44:47], v25 offset:0
    s_waitcnt lgkmcnt(0)
    v_mfma_f32_32x32x16_bf16 v[48:63], v[44:47], v[36:39], v[48:63]
    v_subrev_u32 v24, 256, v24
    v_subrev_u32 v25, 64, v25
    s_add_u32 s35, s35, 1
    s_cmp_lt_u32 s35, s34
    s_cbranch_scc1 L_cl
    s_cmp_eq_u32 s53, 0
    s_cbranch_scc0 L_cr
    v_subrev_u32 v24, 1536, v24
    v_add_u32 v25, 512, v25
    ds_read2_b32 v[96:97], v24 offset0:56 offset1:57
    ds_read2_b32 v[98:99], v24 offset0:58 offset1:59
    ds_read_b128 v[100:103], v25 offset:3120
    ds_read2_b32 v[104:105], v24 offset0:48 offset1:49
    ds_read2_b32 v[106:107], v24 offset0:50 offset1:51
    ds_read_b128 v[108:111], v25 offset:48
    ds_read2_b32 v[112:113], v24 offset0:40 offset1:41
    ds_read2_b32 v[114:115], v24 offset0:42 offset1:43
    ds_read_b128 v[116:119], v25 offset:3104
    v_mov_b32 v88, 0
    s_waitcnt lgkmcnt(6)
    v_mfma_f32_32x32x16_bf16 v[64:79], v[100:103], v[96:99], 0
    s_waitcnt lgkmcnt(3)
    v_mfma_f32_32x32x16_bf16 v[64:79], v[108:111], v[104:107], v[64:79]
    s_waitcnt lgkmcnt(0)
    v_mfma_f32_32x32x16_bf16 v[64:79], v[116:119], v[112:115], v[64:79]
    s_mov_b64 exec, 15
    ds_write_b128 v16, v[88:91]
    s_mov_b64 exec, -1
    s_nop 11
    v_cvt_pk_bf16_f32 v32, v64, v65
    v_cvt_pk_bf16_f32 v33, v66, v67
    v_cvt_pk_bf16_f32 v34, v68, v69
    v_cvt_pk_bf16_f32 v35, v70, v71
    v_cvt_pk_bf16_f32 v36, v72, v73
    v_cvt_pk_bf16_f32 v37, v74, v75
    v_cvt_pk_bf16_f32 v38, v76, v77
    v_cvt_pk_bf16_f32 v39, v78, v79
    ds_write_b16 v20, v32 offset:0
    ds_write_b16_d16_hi v20, v32 offset:64
    ds_write_b16 v20, v33 offset:128
    ds_write_b16_d16_hi v20, v33 offset:192
    ds_write_b16 v20, v34 offset:512
    ds_write_b16_d16_hi v20, v34 offset:576
    ds_write_b16 v20, v35 offset:640
    ds_write_b16_d16_hi v20, v35 offset:704
    ds_write_b16 v20, v36 offset:1024
    ds_write_b16_d16_hi v20, v36 offset:1088
    ds_write_b16 v20, v37 offset:1152
    ds_write_b16_d16_hi v20, v37 offset:1216
    ds_write_b16 v20, v38 offset:1536
    ds_write_b16_d16_hi v20, v38 offset:1600
    ds_write_b16 v20, v39 offset:1664
    ds_write_b16_d16_hi v20, v39 offset:1728
    ds_read2_b32 v[96:97], v21 offset0:128 offset1:129
    ds_read2_b32 v[98:99], v21 offset0:130 offset1:131
    ds_read_b64_tr_b16 v[100:101], v23 offset:0
    ds_read_b64_tr_b16 v[102:103], v23 offset:64
    s_waitcnt lgkmcnt(0)
    v_mfma_f32_32x32x16_bf16 v[64:79], v[96:99], v[100:103], 0
    ds_read2_b32 v[104:105], v21 offset0:136 offset1:137
    ds_read2_b32 v[106:107], v21 offset0:138 offset1:139
    ds_read_b64_tr_b16 v[108:109], v23 offset:256
    ds_read_b64_tr_b16 v[110:111], v23 offset:320
    s_waitcnt lgkmcnt(0)
    v_mfma_f32_32x32x16_bf16 v[64:79], v[104:107], v[108:111], v[64:79]
    ds_read2_b32 v[96:97], v21 offset0:160 offset1:161
    ds_read2_b32 v[98:99], v21 offset0:162 offset1:163
    ds_read_b64_tr_b16 v[100:101], v26 offset:0
    ds_read_b64_tr_b16 v[102:103], v26 offset:64
    s_waitcnt lgkmcnt(0)
    v_mfma_f32_32x32x16_bf16 v[64:79], v[96:99], v[100:103], v[64:79]
    ds_read2_b32 v[104:105], v21 offset0:168 offset1:169
    ds_read2_b32 v[106:107], v21 offset0:170 offset1:171
    ds_read_b64_tr_b16 v[108:109], v26 offset:256
    ds_read_b64_tr_b16 v[110:111], v26 offset:320
    s_waitcnt lgkmcnt(0)
    v_mfma_f32_32x32x16_bf16 v[64:79], v[104:107], v[108:111], v[64:79]
    ds_read2_b32 v[96:97], v21 offset0:0 offset1:1
    ds_read2_b32 v[98:99], v21 offset0:2 offset1:3
    ds_read_b64_tr_b16 v[100:101], v22 offset:48
    ds_read_b64_tr_b16 v[102:103], v22 offset:304
    s_waitcnt lgkmcnt(0)
    v_mfma_f32_32x32x16_bf16 v[64:79], v[96:99], v[100:103], v[64:79]
    ds_read2_b32 v[104:105], v21 offset0:8 offset1:9
    ds_read2_b32 v[106:107], v21 offset0:10 offset1:11
    ds_read_b64_tr_b16 v[108:109], v22 offset:1072
    ds_read_b64_tr_b16 v[110:111], v22 offset:1328
    s_waitcnt lgkmcnt(0)
    v_mfma_f32_32x32x16_bf16 v[64:79], v[104:107], v[108:111], v[64:79]
    ds_read2_b32 v[96:97], v21 offset0:32 offset1:33
    ds_read2_b32 v[98:99], v21 offset0:34 offset1:35
    ds_read_b64_tr_b16 v[100:101], v22 offset:32
    ds_read_b64_tr_b16 v[102:103], v22 offset:288
    s_waitcnt lgkmcnt(0)
    v_mfma_f32_32x32x16_bf16 v[64:79], v[96:99], v[100:103], v[64:79]
    ds_read2_b32 v[104:105], v21 offset0:40 offset1:41
    ds_read2_b32 v[106:107], v21 offset0:42 offset1:43
    ds_read_b64_tr_b16 v[108:109], v22 offset:1056
    ds_read_b64_tr_b16 v[110:111], v22 offset:1312
    s_waitcnt lgkmcnt(0)
    v_mfma_f32_32x32x16_bf16 v[64:79], v[104:107], v[108:111], v[64:79]
    ds_read2_b32 v[96:97], v21 offset0:64 offset1:65
    ds_read2_b32 v[98:99], v21 offset0:66 offset1:67
    ds_read_b64_tr_b16 v[100:101], v22 offset:16
    ds_read_b64_tr_b16 v[102:103], v22 offset:272
    s_waitcnt lgkmcnt(0)
    v_mfma_f32_32x32x16_bf16 v[64:79], v[96:99], v[100:103], v[64:79]
    ds_read2_b32 v[104:105], v21 offset0:72 offset1:73
    ds_read2_b32 v[106:107], v21 offset0:74 offset1:75
    ds_read_b64_tr_b16 v[108:109], v22 offset:1040
    ds_read_b64_tr_b16 v[110:111], v22 offset:1296
    s_waitcnt lgkmcnt(0)
    v_mfma_f32_32x32x16_bf16 v[64:79], v[104:107], v[108:111], v[64:79]
    ds_read2_b32 v[96:97], v21 offset0:96 offset1:97
    ds_read2_b32 v[98:99], v21 offset0:98 offset1:99
    ds_read_b64_tr_b16 v[100:101], v22 offset:0
    ds_read_b64_tr_b16 v[102:103], v22 offset:256
    s_waitcnt lgkmcnt(0)
    v_mfma_f32_32x32x16_bf16 v[64:79], v[96:99], v[100:103], v[64:79]
    ds_read2_b32 v[104:105], v21 offset0:104 offset1:105
    ds_read2_b32 v[106:107], v21 offset0:106 offset1:107
    ds_read_b64_tr_b16 v[108:109], v22 offset:1024
    ds_read_b64_tr_b16 v[110:111], v22 offset:1280
    s_waitcnt lgkmcnt(0)
    v_mfma_f32_32x32x16_bf16 v[64:79], v[104:107], v[108:111], v[64:79]
    s_nop 15
    ds_write_b128 v16, v[64:67] offset:0
    ds_write_b128 v16, v[68:71] offset:1024
    ds_write_b128 v16, v[72:75] offset:2048
    ds_write_b128 v16, v[76:79] offset:3072
    s_waitcnt lgkmcnt(0)
    v_mov_b32 v1, 1
    s_mov_b64 exec, 1
    ds_add_u32 v11, v1 offset:80
    s_mov_b64 exec, -1
    s_branch L_cd
L_cr:
    s_mov_b32 s66, 0
L_sp15:
    ds_read_b32 v1, v11 offset:80
    s_add_u32 s66, s66, 1
    s_waitcnt lgkmcnt(0)
    v_readfirstlane_b32 s67, v1
    s_cmp_ge_u32 s66, 524288
    s_cbranch_scc1 L_se16
    s_cmp_ge_u32 s67, 3
    s_cbranch_scc1 L_se16
    s_sleep 2
    s_branch L_sp15
L_se16:
    ds_read_b128 v[64:67], v17 offset:0
    ds_read_b128 v[68:71], v17 offset:1024
    ds_read_b128 v[72:75], v17 offset:2048
    ds_read_b128 v[76:79], v17 offset:3072
    s_waitcnt lgkmcnt(0)
    v_add_f32 v48, v48, v64
    v_add_f32 v49, v49, v65
    v_add_f32 v50, v50, v66
    v_add_f32 v51, v51, v67
    v_add_f32 v52, v52, v68
    v_add_f32 v53, v53, v69
    v_add_f32 v54, v54, v70
    v_add_f32 v55, v55, v71
    v_add_f32 v56, v56, v72
    v_add_f32 v57, v57, v73
    v_add_f32 v58, v58, v74
    v_add_f32 v59, v59, v75
    v_add_f32 v60, v60, v76
    v_add_f32 v61, v61, v77
    v_add_f32 v62, v62, v78
    v_add_f32 v63, v63, v79
L_cd:
    s_nop 0
    s_mul_i32 s46, s52, 4224
    s_lshl_b32 s47, s53, 11
    s_add_u32 s46, s46, s47
    s_add_u32 s46, s46, 20971520
    s_nop 1
    s_lshl_b32 s47, s53, 9
    s_add_u32 s47, s47, s52
    s_lshl_b32 s47, s47, 6
    s_add_u32 s47, s47, 12648448
    v_mov_b32 v1, s7
    v_mov_b32 v2, 0
    v_cvt_pk_bf16_f32 v32, v48, v49
    v_cvt_pk_bf16_f32 v33, v50, v51
    v_cvt_pk_bf16_f32 v34, v52, v53
    v_cvt_pk_bf16_f32 v35, v54, v55
    v_cvt_pk_bf16_f32 v36, v56, v57
    v_cvt_pk_bf16_f32 v37, v58, v59
    v_cvt_pk_bf16_f32 v38, v60, v61
    v_cvt_pk_bf16_f32 v39, v62, v63
    buffer_store_dword v32, v128, s[8:11], s46 offen offset:0 sc1
    buffer_store_dword v33, v128, s[8:11], s46 offen offset:128 sc1
    buffer_store_dword v34, v128, s[8:11], s46 offen offset:512 sc1
    buffer_store_dword v35, v128, s[8:11], s46 offen offset:640 sc1
    buffer_store_dword v36, v128, s[8:11], s46 offen offset:1024 sc1
    buffer_store_dword v37, v128, s[8:11], s46 offen offset:1152 sc1
    buffer_store_dword v38, v128, s[8:11], s46 offen offset:1536 sc1
    buffer_store_dword v39, v128, s[8:11], s46 offen offset:1664 sc1
    s_waitcnt vmcnt(0) lgkmcnt(0)
    s_mov_b64 exec, 1
    buffer_store_dword v1, v2, s[8:11], s47 offen sc1
    s_mov_b64 exec, -1
    s_lshl_b32 s23, s53, 10
    s_lshl_b32 s24, s61, 11
    s_add_u32 s24, s23, s24
    s_lshl_b32 s26, s5, 7
    s_lshl_b32 s27, s53, 13
    s_add_u32 s26, s26, s27
    s_lshl_b32 s27, s61, 14
    s_add_u32 s26, s26, s27
    s_nop 0
    s_add_u32 s38, s5, 0
    s_and_b32 s38, s38, 7
    s_lshl_b32 s30, s38, 16
    s_add_u32 m0, s24, 0
    s_add_u32 s30, s30, s26
    buffer_load_dwordx4 v125, s[12:15], s30 offen lds
    s_add_u32 m0, s24, 32768
    s_add_u32 s30, s30, 0x8000
    buffer_load_dwordx4 v125, s[12:15], s30 offen lds
    s_waitcnt vmcnt(2)
    s_add_u32 s38, s5, 1
    s_and_b32 s38, s38, 7
    s_lshl_b32 s30, s38, 16
    s_add_u32 m0, s24, 4096
    s_add_u32 s30, s30, s26
    buffer_load_dwordx4 v125, s[12:15], s30 offen lds
    s_add_u32 m0, s24, 36864
    s_add_u32 s30, s30, 0x8000
    buffer_load_dwordx4 v125, s[12:15], s30 offen lds
    s_waitcnt vmcnt(2)
    s_add_u32 s38, s5, 2
    s_and_b32 s38, s38, 7
    s_lshl_b32 s30, s38, 16
    s_add_u32 m0, s24, 8192
    s_add_u32 s30, s30, s26
    buffer_load_dwordx4 v125, s[12:15], s30 offen lds
    s_add_u32 m0, s24, 40960
    s_add_u32 s30, s30, 0x8000
    buffer_load_dwordx4 v125, s[12:15], s30 offen lds
    s_waitcnt vmcnt(2)
    s_add_u32 s38, s5, 3
    s_and_b32 s38, s38, 7
    s_lshl_b32 s30, s38, 16
    s_add_u32 m0, s24, 12288
    s_add_u32 s30, s30, s26
    buffer_load_dwordx4 v125, s[12:15], s30 offen lds
    s_add_u32 m0, s24, 45056
    s_add_u32 s30, s30, 0x8000
    buffer_load_dwordx4 v125, s[12:15], s30 offen lds
    s_waitcnt vmcnt(2)
    s_add_u32 s38, s5, 4
    s_and_b32 s38, s38, 7
    s_lshl_b32 s30, s38, 16
    s_add_u32 m0, s24, 16384
    s_add_u32 s30, s30, s26
    buffer_load_dwordx4 v125, s[12:15], s30 offen lds
    s_add_u32 m0, s24, 49152
    s_add_u32 s30, s30, 0x8000
    buffer_load_dwordx4 v125, s[12:15], s30 offen lds
    s_waitcnt vmcnt(2)
    s_add_u32 s38, s5, 5
    s_and_b32 s38, s38, 7
    s_lshl_b32 s30, s38, 16
    s_add_u32 m0, s24, 20480
    s_add_u32 s30, s30, s26
    buffer_load_dwordx4 v125, s[12:15], s30 offen lds
    s_add_u32 m0, s24, 53248
    s_add_u32 s30, s30, 0x8000
    buffer_load_dwordx4 v125, s[12:15], s30 offen lds
    s_waitcnt vmcnt(2)
    s_add_u32 s38, s5, 6
    s_and_b32 s38, s38, 7
    s_lshl_b32 s30, s38, 16
    s_add_u32 m0, s24, 24576
    s_add_u32 s30, s30, s26
    buffer_load_dwordx4 v125, s[12:15], s30 offen lds
    s_add_u32 m0, s24, 57344
    s_add_u32 s30, s30, 0x8000
    buffer_load_dwordx4 v125, s[12:15], s30 offen lds
    s_waitcnt vmcnt(2)
    s_add_u32 s38, s5, 7
    s_and_b32 s38, s38, 7
    s_lshl_b32 s30, s38, 16
    s_add_u32 m0, s24, 28672
    s_add_u32 s30, s30, s26
    buffer_load_dwordx4 v125, s[12:15], s30 offen lds
    s_add_u32 m0, s24, 61440
    s_add_u32 s30, s30, 0x8000
    buffer_load_dwordx4 v125, s[12:15], s30 offen lds
    s_waitcnt vmcnt(2)
    s_lshr_b32 s46, s4, 4
    s_lshl_b32 s46, s46, 15
    s_lshl_b32 s47, s5, 12
    s_add_u32 s46, s46, s47
    s_add_u32 s46, s46, 12648448
    s_cmp_eq_u32 s3, 0
    s_cbranch_scc0 L_yw
    s_mov_b32 s66, 0
    s_branch L_ft19
L_fp17:
    s_sleep 32
L_ft19:
    buffer_load_dword v1, v127, s[8:11], s46 offen sc1
    s_add_u32 s66, s66, 1
    s_waitcnt vmcnt(0)
    v_cmp_eq_u32 vcc, s7, v1
    s_cmp_ge_u32 s66, 524288
    s_cbranch_scc1 L_fe18
    s_cmp_eq_u64 vcc, -1
    s_cbranch_scc0 L_fp17
L_fe18:
    v_mov_b32 v3, 1
    s_mov_b64 exec, 1
    ds_add_u32 v12, v3 offset:40
    s_mov_b64 exec, -1
L_yw:
    s_mul_i32 s46, s5, 270336
    s_mul_i32 s47, s3, 67584
    s_add_u32 s46, s46, s47
    s_lshl_b32 s47, s4, 7
    s_add_u32 s46, s46, s47
    s_add_u32 s46, s46, 20971520
    s_lshl_b32 s47, s3, 11
    s_add_u32 s47, s47, 74752
    s_mov_b32 s66, 0
L_sp20:
    ds_read_b32 v3, v12 offset:40
    s_add_u32 s66, s66, 1
    s_waitcnt lgkmcnt(0)
    v_readfirstlane_b32 s67, v3
    s_cmp_ge_u32 s66, 524288
    s_cbranch_scc1 L_se21
    s_cmp_ge_u32 s67, 1
    s_cbranch_scc1 L_se21
    s_sleep 8
    s_branch L_sp20
L_se21:
    s_mov_b32 m0, s47
    s_nop 0
    buffer_load_dwordx4 v122, s[8:11], s46 offen sc1 lds
    buffer_load_dwordx4 v123, s[8:11], s46 offen offset:1024 sc1 lds
    s_lshl_b32 s46, s4, 17
    s_lshl_b32 s47, s3, 14
    s_add_u32 s46, s46, s47
    s_lshl_b32 s47, s5, 7
    s_add_u32 s46, s46, s47
    s_add_u32 s47, s46, 0x2000
    s_waitcnt vmcnt(0)
    v_mov_b32 v1, 1
    s_mov_b64 exec, 1
    ds_add_u32 v12, v1 offset:32
    s_mov_b64 exec, -1
    s_mov_b32 s66, 0
L_sp22:
    ds_read_b32 v1, v12 offset:32
    s_add_u32 s66, s66, 1
    s_waitcnt lgkmcnt(0)
    v_readfirstlane_b32 s67, v1
    s_cmp_ge_u32 s66, 524288
    s_cbranch_scc1 L_se23
    s_cmp_ge_u32 s67, 4
    s_cbranch_scc1 L_se23
    s_sleep 1
    s_branch L_sp22
L_se23:
    ds_read_b64_tr_b16 v[32:33], v5
    ds_read_b64_tr_b16 v[34:35], v5 offset:512
    ds_read_b64_tr_b16 v[36:37], v5 offset:4096
    ds_read_b64_tr_b16 v[38:39], v5 offset:4608
    v_xor_b32 v10, 64, v6
    s_waitcnt lgkmcnt(2)
    ds_write_b128 v6, v[32:35]
    s_waitcnt lgkmcnt(1)
    ds_write_b128 v10, v[36:39]
    s_waitcnt lgkmcnt(0)
    ds_read_b128 v[32:35], v7
    ds_read_b128 v[36:39], v7 offset:1024
    s_waitcnt lgkmcnt(1)
    buffer_store_dwordx4 v[32:35], v124, s[16:19], s46 offen sc1
    s_waitcnt lgkmcnt(0)
    buffer_store_dwordx4 v[36:39], v124, s[16:19], s47 offen sc1
    v_mov_b32 v1, 1
    s_mov_b64 exec, 1
    ds_add_u32 v12, v1 offset:44
    s_mov_b64 exec, -1
    s_waitcnt lgkmcnt(0)
    s_endpgm
L_mm:
    s_setprio 3
    s_and_b32 s52, s3, 1
    s_bfe_u32 s53, s3, 0x10001
    v_and_b32 v10, 31, v4
    v_bfe_u32 v11, v4, 1, 3
    v_lshrrev_b32 v12, 5, v4
    v_xor_b32 v11, v11, v12
    v_lshlrev_b32 v11, 4, v11
    v_lshl_add_u32 v10, v10, 7, v11
    s_lshl_b32 s46, s52, 12
    v_add_u32 v160, s46, v10
    v_xor_b32 v161, 32, v160
    v_xor_b32 v162, 64, v160
    v_xor_b32 v163, 96, v160
    v_lshlrev_b32 v10, 10, v12
    v_bfe_u32 v11, v4, 2, 2
    v_lshl_add_u32 v10, v11, 7, v10
    v_bfe_u32 v11, v4, 3, 1
    v_xor_b32 v11, s53, v11
    v_lshl_add_u32 v10, v11, 6, v10
    v_bfe_u32 v11, v4, 4, 1
    v_lshl_add_u32 v10, v11, 5, v10
    v_and_b32 v11, 3, v4
    v_lshl_add_u32 v164, v11, 3, v10
    s_lshl_b32 s46, s4, 1
    s_add_u32 s46, s46, s52
    s_lshl_b32 s46, s46, 10
    s_lshl_b32 s47, s5, 1
    s_add_u32 s47, s47, s53
    s_lshl_b32 s47, s47, 17
    s_add_u32 s46, s46, s47
    v_lshl_add_u32 v165, v4, 4, s46
    v_bfe_u32 v11, v4, 4, 1
    v_lshlrev_b32 v11, 16, v11
    v_lshl_add_u32 v11, v12, 8, v11
    v_and_b32 v10, 15, v4
    v_lshl_add_u32 v11, v10, 4, v11
    v_add_u32 v166, s46, v11
    v_mov_b32 v167, v4
    s_mov_b32 s62, 0x3eb8aa3b
    s_mov_b32 s64, 2097152
    s_mov_b32 s65, 2162688
    s_mov_b32 s63, 4194304
    s_lshl_b32 s54, s52, 12
    s_lshl_b32 s47, s53, 11
    s_add_u32 s54, s54, s47
    s_add_u32 s54, s54, 65536
    s_lshl_b32 s56, s5, 6
    s_add_u32 s56, s56, 12845056
    s_lshl_b32 s55, s4, 9
    s_add_u32 s55, s55, s56
    s_waitcnt lgkmcnt(0)
    s_mov_b32 s8, s38
    s_mov_b32 s9, s39
    s_mov_b32 s10, 0x2000000
    s_mov_b32 s11, 0x00020000
    s_mov_b32 s12, s34
    s_mov_b32 s13, s35
    s_mov_b32 s14, 0x180000
    s_mov_b32 s15, 0x00020000
    v_mul_u32_u24 v126, 3072, v4
    s_and_b32 s46, s4, 7
    s_mul_i32 s46, s46, 196608
    s_lshl_b32 s47, s5, 7
    s_add_u32 s46, s46, s47
    s_xor_b32 s47, s52, 1
    s_lshl_b32 s47, s47, 11
    s_add_u32 s57, s46, s47
    s_cmp_eq_u32 s3, 8
    s_cbranch_scc0 L_pf24
    buffer_load_dword v127, v126, s[12:15], s57 offen
L_pf24:
    s_cmp_eq_u32 s3, 9
    s_cbranch_scc0 L_pf25
    buffer_load_dword v127, v126, s[12:15], s57 offen
L_pf25:
    s_barrier
    ds_read_b128 v[0:3], v160 offset:0
    ds_read_b64_tr_b16 v[144:145], v164 offset:8192
    ds_read_b64_tr_b16 v[146:147], v164 offset:8704
    ds_read_b128 v[4:7], v161 offset:0
    ds_read_b64_tr_b16 v[148:149], v164 offset:10240
    ds_read_b64_tr_b16 v[150:151], v164 offset:10752
    ds_read_b128 v[8:11], v162 offset:0
    ds_read_b64_tr_b16 v[152:153], v164 offset:12288
    ds_read_b64_tr_b16 v[154:155], v164 offset:12800
    ds_read_b128 v[12:15], v163 offset:0
    ds_read_b64_tr_b16 v[156:157], v164 offset:14336
    ds_read_b64_tr_b16 v[158:159], v164 offset:14848
    s_waitcnt lgkmcnt(9)
    v_mfma_f32_32x32x16_bf16 v[128:143], v[144:147], v[0:3], 0
    s_barrier
    ds_read_b128 v[16:19], v160 offset:16384
    ds_read_b64_tr_b16 v[144:145], v164 offset:24576
    ds_read_b64_tr_b16 v[146:147], v164 offset:25088
    s_waitcnt lgkmcnt(9)
    v_mfma_f32_32x32x16_bf16 v[128:143], v[148:151], v[4:7], v[128:143]
    ds_read_b128 v[20:23], v161 offset:16384
    ds_read_b64_tr_b16 v[148:149], v164 offset:26624
    ds_read_b64_tr_b16 v[150:151], v164 offset:27136
    s_waitcnt lgkmcnt(9)
    v_mfma_f32_32x32x16_bf16 v[128:143], v[152:155], v[8:11], v[128:143]
    ds_read_b128 v[24:27], v162 offset:16384
    ds_read_b64_tr_b16 v[152:153], v164 offset:28672
    ds_read_b64_tr_b16 v[154:155], v164 offset:29184
    s_waitcnt lgkmcnt(9)
    v_mfma_f32_32x32x16_bf16 v[128:143], v[156:159], v[12:15], v[128:143]
    ds_read_b128 v[28:31], v163 offset:16384
    ds_read_b64_tr_b16 v[156:157], v164 offset:30720
    ds_read_b64_tr_b16 v[158:159], v164 offset:31232
    s_waitcnt lgkmcnt(9)
    v_mfma_f32_32x32x16_bf16 v[128:143], v[144:147], v[16:19], v[128:143]
    s_barrier
    ds_read_b128 v[32:35], v160 offset:32768
    ds_read_b64_tr_b16 v[144:145], v164 offset:40960
    ds_read_b64_tr_b16 v[146:147], v164 offset:41472
    s_waitcnt lgkmcnt(9)
    v_mfma_f32_32x32x16_bf16 v[128:143], v[148:151], v[20:23], v[128:143]
    ds_read_b128 v[36:39], v161 offset:32768
    ds_read_b64_tr_b16 v[148:149], v164 offset:43008
    ds_read_b64_tr_b16 v[150:151], v164 offset:43520
    s_waitcnt lgkmcnt(9)
    v_mfma_f32_32x32x16_bf16 v[128:143], v[152:155], v[24:27], v[128:143]
    ds_read_b128 v[40:43], v162 offset:32768
    ds_read_b64_tr_b16 v[152:153], v164 offset:45056
    ds_read_b64_tr_b16 v[154:155], v164 offset:45568
    s_waitcnt lgkmcnt(9)
    v_mfma_f32_32x32x16_bf16 v[128:143], v[156:159], v[28:31], v[128:143]
    ds_read_b128 v[44:47], v163 offset:32768
    ds_read_b64_tr_b16 v[156:157], v164 offset:47104
    ds_read_b64_tr_b16 v[158:159], v164 offset:47616
    s_waitcnt lgkmcnt(9)
    v_mfma_f32_32x32x16_bf16 v[128:143], v[144:147], v[32:35], v[128:143]
    s_barrier
    v_add_u32 v160, 0xc000, v160
    v_add_u32 v161, 0xc000, v161
    v_add_u32 v162, 0xc000, v162
    v_add_u32 v163, 0xc000, v163
    v_add_u32 v164, 0xc000, v164
    ds_read_b128 v[48:51], v160 offset:0
    ds_read_b64_tr_b16 v[144:145], v164 offset:8192
    ds_read_b64_tr_b16 v[146:147], v164 offset:8704
    s_waitcnt lgkmcnt(9)
    v_mfma_f32_32x32x16_bf16 v[128:143], v[148:151], v[36:39], v[128:143]
    ds_read_b128 v[52:55], v161 offset:0
    ds_read_b64_tr_b16 v[148:149], v164 offset:10240
    ds_read_b64_tr_b16 v[150:151], v164 offset:10752
    s_waitcnt lgkmcnt(9)
    v_mfma_f32_32x32x16_bf16 v[128:143], v[152:155], v[40:43], v[128:143]
    ds_read_b128 v[56:59], v162 offset:0
    ds_read_b64_tr_b16 v[152:153], v164 offset:12288
    ds_read_b64_tr_b16 v[154:155], v164 offset:12800
    s_waitcnt lgkmcnt(9)
    v_mfma_f32_32x32x16_bf16 v[128:143], v[156:159], v[44:47], v[128:143]
    ds_read_b128 v[60:63], v163 offset:0
    ds_read_b64_tr_b16 v[156:157], v164 offset:14336
    ds_read_b64_tr_b16 v[158:159], v164 offset:14848
    s_waitcnt lgkmcnt(9)
    v_mfma_f32_32x32x16_bf16 v[128:143], v[144:147], v[48:51], v[128:143]
    s_barrier
    ds_read_b128 v[64:67], v160 offset:16384
    ds_read_b64_tr_b16 v[144:145], v164 offset:24576
    ds_read_b64_tr_b16 v[146:147], v164 offset:25088
    s_waitcnt lgkmcnt(9)
    v_mfma_f32_32x32x16_bf16 v[128:143], v[148:151], v[52:55], v[128:143]
    ds_read_b128 v[68:71], v161 offset:16384
    ds_read_b64_tr_b16 v[148:149], v164 offset:26624
    ds_read_b64_tr_b16 v[150:151], v164 offset:27136
    s_waitcnt lgkmcnt(9)
    v_mfma_f32_32x32x16_bf16 v[128:143], v[152:155], v[56:59], v[128:143]
    ds_read_b128 v[72:75], v162 offset:16384
    ds_read_b64_tr_b16 v[152:153], v164 offset:28672
    ds_read_b64_tr_b16 v[154:155], v164 offset:29184
    s_waitcnt lgkmcnt(9)
    v_mfma_f32_32x32x16_bf16 v[128:143], v[156:159], v[60:63], v[128:143]
    ds_read_b128 v[76:79], v163 offset:16384
    ds_read_b64_tr_b16 v[156:157], v164 offset:30720
    ds_read_b64_tr_b16 v[158:159], v164 offset:31232
    s_waitcnt lgkmcnt(9)
    v_mfma_f32_32x32x16_bf16 v[128:143], v[144:147], v[64:67], v[128:143]
    s_barrier
    ds_read_b128 v[80:83], v160 offset:32768
    ds_read_b64_tr_b16 v[144:145], v164 offset:40960
    ds_read_b64_tr_b16 v[146:147], v164 offset:41472
    s_waitcnt lgkmcnt(9)
    v_mfma_f32_32x32x16_bf16 v[128:143], v[148:151], v[68:71], v[128:143]
    ds_read_b128 v[84:87], v161 offset:32768
    ds_read_b64_tr_b16 v[148:149], v164 offset:43008
    ds_read_b64_tr_b16 v[150:151], v164 offset:43520
    s_waitcnt lgkmcnt(9)
    v_mfma_f32_32x32x16_bf16 v[128:143], v[152:155], v[72:75], v[128:143]
    ds_read_b128 v[88:91], v162 offset:32768
    ds_read_b64_tr_b16 v[152:153], v164 offset:45056
    ds_read_b64_tr_b16 v[154:155], v164 offset:45568
    s_waitcnt lgkmcnt(9)
    v_mfma_f32_32x32x16_bf16 v[128:143], v[156:159], v[76:79], v[128:143]
    ds_read_b128 v[92:95], v163 offset:32768
    ds_read_b64_tr_b16 v[156:157], v164 offset:47104
    ds_read_b64_tr_b16 v[158:159], v164 offset:47616
    s_waitcnt lgkmcnt(9)
    v_mfma_f32_32x32x16_bf16 v[128:143], v[144:147], v[80:83], v[128:143]
    s_barrier
    s_waitcnt vmcnt(0)
    v_subrev_u32 v160, 0xc000, v160
    v_subrev_u32 v161, 0xc000, v161
    v_subrev_u32 v162, 0xc000, v162
    v_subrev_u32 v163, 0xc000, v163
    v_subrev_u32 v164, 0xc000, v164
    ds_read_b128 v[96:99], v160 offset:0
    ds_read_b64_tr_b16 v[144:145], v164 offset:8192
    ds_read_b64_tr_b16 v[146:147], v164 offset:8704
    s_waitcnt lgkmcnt(9)
    v_mfma_f32_32x32x16_bf16 v[128:143], v[148:151], v[84:87], v[128:143]
    ds_read_b128 v[100:103], v161 offset:0
    ds_read_b64_tr_b16 v[148:149], v164 offset:10240
    ds_read_b64_tr_b16 v[150:151], v164 offset:10752
    s_waitcnt lgkmcnt(9)
    v_mfma_f32_32x32x16_bf16 v[128:143], v[152:155], v[88:91], v[128:143]
    ds_read_b128 v[104:107], v162 offset:0
    ds_read_b64_tr_b16 v[152:153], v164 offset:12288
    ds_read_b64_tr_b16 v[154:155], v164 offset:12800
    s_waitcnt lgkmcnt(9)
    v_mfma_f32_32x32x16_bf16 v[128:143], v[156:159], v[92:95], v[128:143]
    ds_read_b128 v[108:111], v163 offset:0
    ds_read_b64_tr_b16 v[156:157], v164 offset:14336
    ds_read_b64_tr_b16 v[158:159], v164 offset:14848
    s_waitcnt lgkmcnt(9)
    v_mfma_f32_32x32x16_bf16 v[128:143], v[144:147], v[96:99], v[128:143]
    s_barrier
    ds_read_b128 v[112:115], v160 offset:16384
    ds_read_b64_tr_b16 v[144:145], v164 offset:24576
    ds_read_b64_tr_b16 v[146:147], v164 offset:25088
    s_waitcnt lgkmcnt(9)
    v_mfma_f32_32x32x16_bf16 v[128:143], v[148:151], v[100:103], v[128:143]
    ds_read_b128 v[116:119], v161 offset:16384
    ds_read_b64_tr_b16 v[148:149], v164 offset:26624
    ds_read_b64_tr_b16 v[150:151], v164 offset:27136
    s_waitcnt lgkmcnt(9)
    v_mfma_f32_32x32x16_bf16 v[128:143], v[152:155], v[104:107], v[128:143]
    ds_read_b128 v[120:123], v162 offset:16384
    ds_read_b64_tr_b16 v[152:153], v164 offset:28672
    ds_read_b64_tr_b16 v[154:155], v164 offset:29184
    s_waitcnt lgkmcnt(9)
    v_mfma_f32_32x32x16_bf16 v[128:143], v[156:159], v[108:111], v[128:143]
    ds_read_b128 v[124:127], v163 offset:16384
    ds_read_b64_tr_b16 v[156:157], v164 offset:30720
    ds_read_b64_tr_b16 v[158:159], v164 offset:31232
    s_waitcnt lgkmcnt(9)
    v_mfma_f32_32x32x16_bf16 v[128:143], v[144:147], v[112:115], v[128:143]
    s_barrier
    ds_read_b64_tr_b16 v[144:145], v164 offset:32768
    ds_read_b64_tr_b16 v[146:147], v164 offset:33280
    s_waitcnt lgkmcnt(8)
    v_mfma_f32_32x32x16_bf16 v[128:143], v[148:151], v[116:119], v[128:143]
    ds_read_b64_tr_b16 v[148:149], v164 offset:34816
    ds_read_b64_tr_b16 v[150:151], v164 offset:35328
    s_waitcnt lgkmcnt(7)
    v_mfma_f32_32x32x16_bf16 v[128:143], v[152:155], v[120:123], v[128:143]
    ds_read_b64_tr_b16 v[152:153], v164 offset:36864
    ds_read_b64_tr_b16 v[154:155], v164 offset:37376
    s_waitcnt lgkmcnt(6)
    v_mfma_f32_32x32x16_bf16 v[128:143], v[156:159], v[124:127], v[128:143]
    s_load_dword s7, s[36:37], 0
    s_nop 15
    v_cvt_pk_bf16_f32 v128, v128, v129
    v_cvt_pk_bf16_f32 v129, v130, v131
    v_cvt_pk_bf16_f32 v130, v132, v133
    v_cvt_pk_bf16_f32 v131, v134, v135
    v_cvt_pk_bf16_f32 v132, v136, v137
    v_cvt_pk_bf16_f32 v133, v138, v139
    v_cvt_pk_bf16_f32 v134, v140, v141
    v_cvt_pk_bf16_f32 v135, v142, v143
    s_waitcnt lgkmcnt(0)
    buffer_store_dwordx4 v[128:131], v165, s[8:11], s64 offen sc1
    buffer_store_dwordx4 v[132:135], v165, s[8:11], s65 offen sc1
    ds_read_b64_tr_b16 v[156:157], v164 offset:38912
    ds_read_b64_tr_b16 v[158:159], v164 offset:39424
    s_waitcnt lgkmcnt(6)
    v_mfma_f32_32x32x16_bf16 v[128:143], v[0:3], v[144:147], 0
    ds_read_b64_tr_b16 v[144:145], v164 offset:40960
    ds_read_b64_tr_b16 v[146:147], v164 offset:41472
    s_waitcnt lgkmcnt(6)
    v_mfma_f32_32x32x16_bf16 v[128:143], v[4:7], v[148:151], v[128:143]
    ds_read_b64_tr_b16 v[148:149], v164 offset:43008
    ds_read_b64_tr_b16 v[150:151], v164 offset:43520
    s_waitcnt lgkmcnt(6)
    v_mfma_f32_32x32x16_bf16 v[128:143], v[8:11], v[152:155], v[128:143]
    ds_read_b64_tr_b16 v[152:153], v164 offset:45056
    ds_read_b64_tr_b16 v[154:155], v164 offset:45568
    s_waitcnt lgkmcnt(6)
    v_mfma_f32_32x32x16_bf16 v[128:143], v[12:15], v[156:159], v[128:143]
    ds_read_b64_tr_b16 v[156:157], v164 offset:47104
    ds_read_b64_tr_b16 v[158:159], v164 offset:47616
    s_waitcnt lgkmcnt(6)
    v_mfma_f32_32x32x16_bf16 v[128:143], v[16:19], v[144:147], v[128:143]
    s_barrier
    v_add_u32 v164, 0xc000, v164
    ds_read_b64_tr_b16 v[144:145], v164 offset:0
    ds_read_b64_tr_b16 v[146:147], v164 offset:512
    s_waitcnt lgkmcnt(6)
    v_mfma_f32_32x32x16_bf16 v[128:143], v[20:23], v[148:151], v[128:143]
    ds_read_b64_tr_b16 v[148:149], v164 offset:2048
    ds_read_b64_tr_b16 v[150:151], v164 offset:2560
    s_waitcnt lgkmcnt(6)
    v_mfma_f32_32x32x16_bf16 v[128:143], v[24:27], v[152:155], v[128:143]
    ds_read_b64_tr_b16 v[152:153], v164 offset:4096
    ds_read_b64_tr_b16 v[154:155], v164 offset:4608
    s_waitcnt lgkmcnt(6)
    v_mfma_f32_32x32x16_bf16 v[128:143], v[28:31], v[156:159], v[128:143]
    ds_read_b64_tr_b16 v[156:157], v164 offset:6144
    ds_read_b64_tr_b16 v[158:159], v164 offset:6656
    s_waitcnt lgkmcnt(6)
    v_mfma_f32_32x32x16_bf16 v[128:143], v[32:35], v[144:147], v[128:143]
    ds_read_b64_tr_b16 v[144:145], v164 offset:8192
    ds_read_b64_tr_b16 v[146:147], v164 offset:8704
    s_waitcnt lgkmcnt(6)
    v_mfma_f32_32x32x16_bf16 v[128:143], v[36:39], v[148:151], v[128:143]
    ds_read_b64_tr_b16 v[148:149], v164 offset:10240
    ds_read_b64_tr_b16 v[150:151], v164 offset:10752
    s_waitcnt lgkmcnt(6)
    v_mfma_f32_32x32x16_bf16 v[128:143], v[40:43], v[152:155], v[128:143]
    ds_read_b64_tr_b16 v[152:153], v164 offset:12288
    ds_read_b64_tr_b16 v[154:155], v164 offset:12800
    s_waitcnt lgkmcnt(6)
    v_mfma_f32_32x32x16_bf16 v[128:143], v[44:47], v[156:159], v[128:143]
    ds_read_b64_tr_b16 v[156:157], v164 offset:14336
    ds_read_b64_tr_b16 v[158:159], v164 offset:14848
    s_waitcnt lgkmcnt(6)
    v_mfma_f32_32x32x16_bf16 v[128:143], v[48:51], v[144:147], v[128:143]
    s_barrier
    ds_read_b64_tr_b16 v[144:145], v164 offset:16384
    ds_read_b64_tr_b16 v[146:147], v164 offset:16896
    s_waitcnt lgkmcnt(6)
    v_mfma_f32_32x32x16_bf16 v[128:143], v[52:55], v[148:151], v[128:143]
    ds_read_b64_tr_b16 v[148:149], v164 offset:18432
    ds_read_b64_tr_b16 v[150:151], v164 offset:18944
    s_waitcnt lgkmcnt(6)
    v_mfma_f32_32x32x16_bf16 v[128:143], v[56:59], v[152:155], v[128:143]
    ds_read_b64_tr_b16 v[152:153], v164 offset:20480
    ds_read_b64_tr_b16 v[154:155], v164 offset:20992
    s_waitcnt lgkmcnt(6)
    v_mfma_f32_32x32x16_bf16 v[128:143], v[60:63], v[156:159], v[128:143]
    ds_read_b64_tr_b16 v[156:157], v164 offset:22528
    ds_read_b64_tr_b16 v[158:159], v164 offset:23040
    s_waitcnt lgkmcnt(6)
    v_mfma_f32_32x32x16_bf16 v[128:143], v[64:67], v[144:147], v[128:143]
    ds_read_b64_tr_b16 v[144:145], v164 offset:24576
    ds_read_b64_tr_b16 v[146:147], v164 offset:25088
    s_waitcnt lgkmcnt(6)
    v_mfma_f32_32x32x16_bf16 v[128:143], v[68:71], v[148:151], v[128:143]
    ds_read_b64_tr_b16 v[148:149], v164 offset:26624
    ds_read_b64_tr_b16 v[150:151], v164 offset:27136
    s_waitcnt lgkmcnt(6)
    v_mfma_f32_32x32x16_bf16 v[128:143], v[72:75], v[152:155], v[128:143]
    ds_read_b64_tr_b16 v[152:153], v164 offset:28672
    ds_read_b64_tr_b16 v[154:155], v164 offset:29184
    s_waitcnt lgkmcnt(6)
    v_mfma_f32_32x32x16_bf16 v[128:143], v[76:79], v[156:159], v[128:143]
    ds_read_b64_tr_b16 v[156:157], v164 offset:30720
    ds_read_b64_tr_b16 v[158:159], v164 offset:31232
    s_waitcnt lgkmcnt(6)
    v_mfma_f32_32x32x16_bf16 v[128:143], v[80:83], v[144:147], v[128:143]
    s_barrier
    ds_read_b64_tr_b16 v[144:145], v164 offset:32768
    ds_read_b64_tr_b16 v[146:147], v164 offset:33280
    s_waitcnt lgkmcnt(6)
    v_mfma_f32_32x32x16_bf16 v[128:143], v[84:87], v[148:151], v[128:143]
    ds_read_b64_tr_b16 v[148:149], v164 offset:34816
    ds_read_b64_tr_b16 v[150:151], v164 offset:35328
    s_waitcnt lgkmcnt(6)
    v_mfma_f32_32x32x16_bf16 v[128:143], v[88:91], v[152:155], v[128:143]
    ds_read_b64_tr_b16 v[152:153], v164 offset:36864
    ds_read_b64_tr_b16 v[154:155], v164 offset:37376
    s_waitcnt lgkmcnt(6)
    v_mfma_f32_32x32x16_bf16 v[128:143], v[92:95], v[156:159], v[128:143]
    ds_read_b64_tr_b16 v[156:157], v164 offset:38912
    ds_read_b64_tr_b16 v[158:159], v164 offset:39424
    s_waitcnt lgkmcnt(6)
    v_mfma_f32_32x32x16_bf16 v[128:143], v[96:99], v[144:147], v[128:143]
    ds_read_b64_tr_b16 v[144:145], v164 offset:40960
    ds_read_b64_tr_b16 v[146:147], v164 offset:41472
    s_waitcnt lgkmcnt(6)
    v_mfma_f32_32x32x16_bf16 v[128:143], v[100:103], v[148:151], v[128:143]
    ds_read_b64_tr_b16 v[148:149], v164 offset:43008
    ds_read_b64_tr_b16 v[150:151], v164 offset:43520
    s_waitcnt lgkmcnt(6)
    v_mfma_f32_32x32x16_bf16 v[128:143], v[104:107], v[152:155], v[128:143]
    ds_read_b64_tr_b16 v[152:153], v164 offset:45056
    ds_read_b64_tr_b16 v[154:155], v164 offset:45568
    s_waitcnt lgkmcnt(6)
    v_mfma_f32_32x32x16_bf16 v[128:143], v[108:111], v[156:159], v[128:143]
    ds_read_b64_tr_b16 v[156:157], v164 offset:47104
    ds_read_b64_tr_b16 v[158:159], v164 offset:47616
    s_waitcnt lgkmcnt(6)
    v_mfma_f32_32x32x16_bf16 v[128:143], v[112:115], v[144:147], v[128:143]
    s_barrier
    v_subrev_u32 v164, 0xc000, v164
    ds_read_b64_tr_b16 v[144:145], v164 offset:0
    ds_read_b64_tr_b16 v[146:147], v164 offset:512
    s_waitcnt lgkmcnt(6)
    v_mfma_f32_32x32x16_bf16 v[128:143], v[116:119], v[148:151], v[128:143]
    ds_read_b64_tr_b16 v[148:149], v164 offset:2048
    ds_read_b64_tr_b16 v[150:151], v164 offset:2560
    s_waitcnt lgkmcnt(6)
    v_mfma_f32_32x32x16_bf16 v[128:143], v[120:123], v[152:155], v[128:143]
    ds_read_b64_tr_b16 v[152:153], v164 offset:4096
    ds_read_b64_tr_b16 v[154:155], v164 offset:4608
    s_waitcnt lgkmcnt(6)
    v_mfma_f32_32x32x16_bf16 v[128:143], v[124:127], v[156:159], v[128:143]
    s_nop 15
    v_cvt_pk_bf16_f32 v128, v128, v129
    v_cvt_pk_bf16_f32 v129, v130, v131
    v_cvt_pk_bf16_f32 v130, v132, v133
    v_cvt_pk_bf16_f32 v131, v134, v135
    v_cvt_pk_bf16_f32 v132, v136, v137
    v_cvt_pk_bf16_f32 v133, v138, v139
    v_cvt_pk_bf16_f32 v134, v140, v141
    v_cvt_pk_bf16_f32 v135, v142, v143
    buffer_store_dwordx4 v[128:131], v166, s[8:11], s63 offen sc1
    buffer_store_dwordx4 v[132:135], v166, s[8:11], s63 offen offset:512 sc1
    ds_read_b64_tr_b16 v[156:157], v164 offset:6144
    ds_read_b64_tr_b16 v[158:159], v164 offset:6656
    s_waitcnt lgkmcnt(6)
    v_mfma_f32_32x32x16_bf16 v[128:143], v[144:147], v[0:3], 0
    ds_read_b64_tr_b16 v[144:145], v164 offset:8192
    ds_read_b64_tr_b16 v[146:147], v164 offset:8704
    s_waitcnt lgkmcnt(6)
    v_mfma_f32_32x32x16_bf16 v[128:143], v[148:151], v[4:7], v[128:143]
    ds_read_b64_tr_b16 v[148:149], v164 offset:10240
    ds_read_b64_tr_b16 v[150:151], v164 offset:10752
    s_waitcnt lgkmcnt(6)
    v_mfma_f32_32x32x16_bf16 v[128:143], v[152:155], v[8:11], v[128:143]
    ds_read_b64_tr_b16 v[152:153], v164 offset:12288
    ds_read_b64_tr_b16 v[154:155], v164 offset:12800
    s_waitcnt lgkmcnt(6)
    v_mfma_f32_32x32x16_bf16 v[128:143], v[156:159], v[12:15], v[128:143]
    ds_read_b64_tr_b16 v[156:157], v164 offset:14336
    ds_read_b64_tr_b16 v[158:159], v164 offset:14848
    s_waitcnt lgkmcnt(6)
    v_mfma_f32_32x32x16_bf16 v[128:143], v[144:147], v[16:19], v[128:143]
    s_waitcnt vmcnt(0)
    s_barrier
    s_cmp_eq_u32 s3, 8
    s_cbranch_scc0 L_npk
    s_cmp_lg_u32 s7, 0
    s_cbranch_scc1 L_te
    s_mov_b32 s12, s36
    s_mov_b32 s13, s37
    s_mov_b32 s14, 256
    v_mov_b32 v2, 0
    s_mov_b32 s66, 0
L_tg:
    buffer_load_dword v1, v2, s[12:15], 0 offen sc1
    s_add_u32 s66, s66, 1
    s_waitcnt vmcnt(0)
    v_readfirstlane_b32 s7, v1
    s_cmp_ge_u32 s66, 524288
    s_cbranch_scc1 L_te
    s_cmp_eq_u32 s7, 0
    s_cbranch_scc1 L_tg
    s_nop 1
L_te:
    s_mov_b64 exec, 15
    v_mbcnt_lo_u32_b32 v2, -1, 0
    v_mov_b32 v1, s7
    v_lshlrev_b32 v2, 14, v2
    buffer_store_dword v1, v2, s[8:11], s55 offen sc1
    s_mov_b64 exec, -1
L_npk:
    ds_read_b64_tr_b16 v[144:145], v164 offset:16384
    ds_read_b64_tr_b16 v[146:147], v164 offset:16896
    s_waitcnt lgkmcnt(6)
    v_mfma_f32_32x32x16_bf16 v[128:143], v[148:151], v[20:23], v[128:143]
    ds_read_b64_tr_b16 v[148:149], v164 offset:18432
    ds_read_b64_tr_b16 v[150:151], v164 offset:18944
    s_waitcnt lgkmcnt(6)
    v_mfma_f32_32x32x16_bf16 v[128:143], v[152:155], v[24:27], v[128:143]
    ds_read_b64_tr_b16 v[152:153], v164 offset:20480
    ds_read_b64_tr_b16 v[154:155], v164 offset:20992
    s_waitcnt lgkmcnt(6)
    v_mfma_f32_32x32x16_bf16 v[128:143], v[156:159], v[28:31], v[128:143]
    ds_read_b64_tr_b16 v[156:157], v164 offset:22528
    ds_read_b64_tr_b16 v[158:159], v164 offset:23040
    s_waitcnt lgkmcnt(6)
    v_mfma_f32_32x32x16_bf16 v[128:143], v[144:147], v[32:35], v[128:143]
    ds_read_b64_tr_b16 v[144:145], v164 offset:24576
    ds_read_b64_tr_b16 v[146:147], v164 offset:25088
    s_waitcnt lgkmcnt(6)
    v_mfma_f32_32x32x16_bf16 v[128:143], v[148:151], v[36:39], v[128:143]
    ds_read_b64_tr_b16 v[148:149], v164 offset:26624
    ds_read_b64_tr_b16 v[150:151], v164 offset:27136
    s_waitcnt lgkmcnt(6)
    v_mfma_f32_32x32x16_bf16 v[128:143], v[152:155], v[40:43], v[128:143]
    ds_read_b64_tr_b16 v[152:153], v164 offset:28672
    ds_read_b64_tr_b16 v[154:155], v164 offset:29184
    s_waitcnt lgkmcnt(6)
    v_mfma_f32_32x32x16_bf16 v[128:143], v[156:159], v[44:47], v[128:143]
    ds_read_b64_tr_b16 v[156:157], v164 offset:30720
    ds_read_b64_tr_b16 v[158:159], v164 offset:31232
    s_waitcnt lgkmcnt(6)
    v_mfma_f32_32x32x16_bf16 v[128:143], v[144:147], v[48:51], v[128:143]
    s_barrier
    ds_read_b64_tr_b16 v[144:145], v164 offset:32768
    ds_read_b64_tr_b16 v[146:147], v164 offset:33280
    s_waitcnt lgkmcnt(6)
    v_mfma_f32_32x32x16_bf16 v[128:143], v[148:151], v[52:55], v[128:143]
    ds_read_b64_tr_b16 v[148:149], v164 offset:34816
    ds_read_b64_tr_b16 v[150:151], v164 offset:35328
    s_waitcnt lgkmcnt(6)
    v_mfma_f32_32x32x16_bf16 v[128:143], v[152:155], v[56:59], v[128:143]
    ds_read_b64_tr_b16 v[152:153], v164 offset:36864
    ds_read_b64_tr_b16 v[154:155], v164 offset:37376
    s_waitcnt lgkmcnt(6)
    v_mfma_f32_32x32x16_bf16 v[128:143], v[156:159], v[60:63], v[128:143]
    ds_read_b64_tr_b16 v[156:157], v164 offset:38912
    ds_read_b64_tr_b16 v[158:159], v164 offset:39424
    s_waitcnt lgkmcnt(6)
    v_mfma_f32_32x32x16_bf16 v[128:143], v[144:147], v[64:67], v[128:143]
    v_mov_b32 v12, 94208
    ds_read_b32 v1, v12 offset:0
    s_waitcnt lgkmcnt(0)
    v_readfirstlane_b32 s7, v1
    ds_read_b64_tr_b16 v[144:145], v164 offset:40960
    ds_read_b64_tr_b16 v[146:147], v164 offset:41472
    s_waitcnt lgkmcnt(6)
    v_mfma_f32_32x32x16_bf16 v[128:143], v[148:151], v[68:71], v[128:143]
    ds_read_b64_tr_b16 v[148:149], v164 offset:43008
    ds_read_b64_tr_b16 v[150:151], v164 offset:43520
    s_waitcnt lgkmcnt(6)
    v_mfma_f32_32x32x16_bf16 v[128:143], v[152:155], v[72:75], v[128:143]
    ds_read_b64_tr_b16 v[152:153], v164 offset:45056
    ds_read_b64_tr_b16 v[154:155], v164 offset:45568
    s_waitcnt lgkmcnt(6)
    v_mfma_f32_32x32x16_bf16 v[128:143], v[156:159], v[76:79], v[128:143]
    ds_read_b64_tr_b16 v[156:157], v164 offset:47104
    ds_read_b64_tr_b16 v[158:159], v164 offset:47616
    s_waitcnt lgkmcnt(6)
    v_mfma_f32_32x32x16_bf16 v[128:143], v[144:147], v[80:83], v[128:143]
    s_barrier
    v_add_u32 v164, 0xc000, v164
    ds_read_b64_tr_b16 v[144:145], v164 offset:0
    ds_read_b64_tr_b16 v[146:147], v164 offset:512
    s_waitcnt lgkmcnt(6)
    v_mfma_f32_32x32x16_bf16 v[128:143], v[148:151], v[84:87], v[128:143]
    ds_read_b64_tr_b16 v[148:149], v164 offset:2048
    ds_read_b64_tr_b16 v[150:151], v164 offset:2560
    s_waitcnt lgkmcnt(6)
    v_mfma_f32_32x32x16_bf16 v[128:143], v[152:155], v[88:91], v[128:143]
    ds_read_b64_tr_b16 v[152:153], v164 offset:4096
    ds_read_b64_tr_b16 v[154:155], v164 offset:4608
    s_waitcnt lgkmcnt(6)
    v_mfma_f32_32x32x16_bf16 v[128:143], v[156:159], v[92:95], v[128:143]
    ds_read_b64_tr_b16 v[156:157], v164 offset:6144
    ds_read_b64_tr_b16 v[158:159], v164 offset:6656
    s_waitcnt lgkmcnt(6)
    v_mfma_f32_32x32x16_bf16 v[128:143], v[144:147], v[96:99], v[128:143]
    ds_read_b64_tr_b16 v[144:145], v164 offset:8192
    ds_read_b64_tr_b16 v[146:147], v164 offset:8704
    s_waitcnt lgkmcnt(6)
    v_mfma_f32_32x32x16_bf16 v[128:143], v[148:151], v[100:103], v[128:143]
    ds_read_b64_tr_b16 v[148:149], v164 offset:10240
    ds_read_b64_tr_b16 v[150:151], v164 offset:10752
    s_waitcnt lgkmcnt(6)
    v_mfma_f32_32x32x16_bf16 v[128:143], v[152:155], v[104:107], v[128:143]
    ds_read_b64_tr_b16 v[152:153], v164 offset:12288
    ds_read_b64_tr_b16 v[154:155], v164 offset:12800
    s_waitcnt lgkmcnt(6)
    v_mfma_f32_32x32x16_bf16 v[128:143], v[156:159], v[108:111], v[128:143]
    ds_read_b64_tr_b16 v[156:157], v164 offset:14336
    ds_read_b64_tr_b16 v[158:159], v164 offset:14848
    s_waitcnt lgkmcnt(6)
    v_mfma_f32_32x32x16_bf16 v[128:143], v[144:147], v[112:115], v[128:143]
    s_waitcnt lgkmcnt(4)
    v_mfma_f32_32x32x16_bf16 v[128:143], v[148:151], v[116:119], v[128:143]
    s_waitcnt lgkmcnt(2)
    v_mfma_f32_32x32x16_bf16 v[128:143], v[152:155], v[120:123], v[128:143]
    s_waitcnt lgkmcnt(0)
    v_mfma_f32_32x32x16_bf16 v[128:143], v[156:159], v[124:127], v[128:143]
    v_mov_b32 v4, v167
    v_lshl_add_u32 v10, v167, 4, s54
    s_nop 13
    v_mul_f32 v128, s62, v128
    v_mul_f32 v129, s62, v129
    v_mul_f32 v130, s62, v130
    v_mul_f32 v131, s62, v131
    v_mul_f32 v132, s62, v132
    v_mul_f32 v133, s62, v133
    v_mul_f32 v134, s62, v134
    v_mul_f32 v135, s62, v135
    v_mul_f32 v136, s62, v136
    v_mul_f32 v137, s62, v137
    v_mul_f32 v138, s62, v138
    v_mul_f32 v139, s62, v139
    v_mul_f32 v140, s62, v140
    v_mul_f32 v141, s62, v141
    v_mul_f32 v142, s62, v142
    v_mul_f32 v143, s62, v143
    v_cvt_pk_bf16_f32 v128, v128, v129
    v_cvt_pk_bf16_f32 v129, v130, v131
    v_cvt_pk_bf16_f32 v130, v132, v133
    v_cvt_pk_bf16_f32 v131, v134, v135
    v_cvt_pk_bf16_f32 v132, v136, v137
    v_cvt_pk_bf16_f32 v133, v138, v139
    v_cvt_pk_bf16_f32 v134, v140, v141
    v_cvt_pk_bf16_f32 v135, v142, v143
    ds_write_b128 v10, v[128:131]
    ds_write_b128 v10, v[132:135] offset:1024
    s_waitcnt lgkmcnt(0)
    s_barrier
    s_cmp_eq_u32 s3, 8
    s_cbranch_scc0 L_apro
    v_and_b32 v6, 31, v4
    v_lshlrev_b32 v6, 9, v6
    s_lshr_b32 s46, s4, 3
    s_lshl_b32 s46, s46, 14
    s_add_u32 s56, s56, s46
    s_mov_b32 s66, 0
L_fp26:
    s_sleep 4
L_ft28:
    buffer_load_dword v1, v6, s[8:11], s56 offen sc1
    s_add_u32 s66, s66, 1
    s_waitcnt vmcnt(0)
    v_cmp_eq_u32 vcc, s7, v1
    s_cmp_ge_u32 s66, 524288
    s_cbranch_scc1 L_fe27
    s_cmp_eq_u64 vcc, -1
    s_cbranch_scc0 L_fp26
L_fe27:
    v_mov_b32 v3, 1
    s_mov_b64 exec, 1
    ds_add_u32 v12, v3 offset:8
    s_mov_b64 exec, -1
L_apro:
    s_lshr_b32 s19, s3, 3
    s_and_b32 s18, s3, 1
    s_lshl_b32 s24, s19, 1
    s_add_u32 s18, s18, s24
    s_bfe_u32 s24, s3, 0x10001
    v_lshlrev_b32 v5, 4, v4
    s_lshl_b32 s26, s18, 10
    s_add_u32 s26, s26, 65536
    s_lshl_b32 s27, s24, 12
    s_add_u32 s26, s26, s27
    v_add_u32 v13, s26, v5
    s_lshl_b32 s27, s5, 2
    s_add_u32 s18, s18, s27
    s_lshl_b32 s22, s18, 16
    s_add_u32 s27, s22, 2097152
    v_add_u32 v14, s27, v5
    s_lshl_b32 s36, s24, 10
    s_mov_b32 s37, s36
    v_lshrrev_b32 v6, 5, v4
    v_and_b32 v7, 15, v4
    v_lshlrev_b32 v7, 4, v7
    v_lshl_add_u32 v7, v6, 8, v7
    s_add_u32 s27, s22, 4194304
    v_add_u32 v15, s27, v7
    v_and_b32 v6, 31, v4
    v_cmp_eq_u32 vcc, 16, v6
    v_cmp_eq_u32 s[28:29], 20, v6
    s_mov_b32 s30, 0x3f803f80
    s_or_b64 vcc, vcc, s[28:29]
    v_mov_b32 v7, s30
    s_mov_b32 s40, 0xffff
    s_mov_b32 s41, 0xffff
    v_cndmask_b32 v6, 0, v7, vcc
    v_mov_b32 v120, v6
    v_mov_b32 v121, v6
    v_mov_b32 v122, v6
    v_mov_b32 v123, v6
    v_mov_b32 v124, v6
    v_mov_b32 v125, v6
    v_mov_b32 v126, v6
    v_mov_b32 v127, v6
    v_mov_b32 v128, v6
    v_mov_b32 v129, v6
    v_mov_b32 v130, v6
    v_mov_b32 v131, v6
    v_mov_b32 v132, v6
    v_mov_b32 v133, v6
    v_mov_b32 v134, v6
    v_mov_b32 v135, v6
    v_mov_b32 v136, v6
    v_mov_b32 v137, v6
    v_mov_b32 v138, v6
    v_mov_b32 v139, v6
    v_mov_b32 v140, v6
    v_mov_b32 v141, v6
    v_mov_b32 v142, v6
    v_mov_b32 v143, v6
    v_mov_b32 v144, v6
    v_mov_b32 v145, v6
    v_mov_b32 v146, v6
    v_mov_b32 v147, v6
    v_mov_b32 v148, v6
    v_mov_b32 v149, v6
    v_mov_b32 v150, v6
    v_mov_b32 v151, v6
    v_mov_b32 v64, 0
    v_mov_b32 v65, 0
    v_mov_b32 v66, 0
    v_mov_b32 v67, 0
    v_mov_b32 v68, 0
    v_mov_b32 v69, 0
    v_mov_b32 v70, 0
    v_mov_b32 v71, 0
    v_mov_b32 v72, 0
    v_mov_b32 v73, 0
    v_mov_b32 v74, 0
    v_mov_b32 v75, 0
    v_mov_b32 v76, 0
    v_mov_b32 v77, 0
    v_mov_b32 v78, 0
    v_mov_b32 v79, 0
    v_mov_b32 v80, 0
    v_mov_b32 v81, 0
    v_mov_b32 v82, 0
    v_mov_b32 v83, 0
    v_mov_b32 v84, 0
    v_mov_b32 v85, 0
    v_mov_b32 v86, 0
    v_mov_b32 v87, 0
    v_mov_b32 v88, 0
    v_mov_b32 v89, 0
    v_mov_b32 v90, 0
    v_mov_b32 v91, 0
    v_mov_b32 v92, 0
    v_mov_b32 v93, 0
    v_mov_b32 v94, 0
    v_mov_b32 v95, 0
    v_mov_b32 v163, 0
    s_mov_b32 s52, 12615680
    s_lshl_b32 s54, s4, 1
    s_add_u32 s54, s54, s24
    s_lshl_b32 s54, s54, 15
    s_lshl_b32 s26, s18, 10
    s_add_u32 s54, s54, s26
    s_add_u32 s54, s54, 6291456
    v_mov_b32 v8, -1
    v_mov_b32 v9, -1
    v_mov_b32 v10, -1
    v_mov_b32 v11, -1
    s_lshl_b32 s55, s4, 3
    s_add_u32 s55, s55, s5
    s_lshl_b32 s55, s55, 7
    s_add_u32 s55, s55, 12615680
    buffer_store_dwordx4 v[8:11], v5, s[8:11], s54 offen sc1
L_att:
    v_xor_b32 v6, 0x1000, v13
    ds_read_b128 v[100:103], v13
    ds_read_b128 v[96:99], v6
    s_mov_b32 s66, 0
L_sp29:
    ds_read_b32 v3, v12 offset:8
    s_add_u32 s66, s66, 1
    s_waitcnt lgkmcnt(0)
    v_readfirstlane_b32 s67, v3
    s_cmp_ge_u32 s66, 524288
    s_cbranch_scc1 L_se30
    s_cmp_ge_u32 s67, 1
    s_cbranch_scc1 L_se30
    s_sleep 1
    s_branch L_sp29
L_se30:
    buffer_load_dwordx4 v[104:107], v14, s[8:11], s36 offen sc1
    s_add_u32 s36, s36, 2048
    buffer_load_dwordx4 v[108:111], v14, s[8:11], s36 offen sc1
    s_add_u32 s36, s36, 2048
    s_mov_b64 exec, s[40:41]
    buffer_load_dwordx4 v[120:123], v15, s[8:11], s37 offen sc1
    buffer_load_dwordx4 v[124:127], v15, s[8:11], s37 offen offset:512 sc1
    s_mov_b64 exec, -1
    s_add_u32 s37, s37, 2048
    buffer_load_dwordx4 v[112:115], v14, s[8:11], s36 offen sc1
    s_add_u32 s36, s36, 2048
    s_mov_b64 exec, s[40:41]
    buffer_load_dwordx4 v[128:131], v15, s[8:11], s37 offen sc1
    buffer_load_dwordx4 v[132:135], v15, s[8:11], s37 offen offset:512 sc1
    s_mov_b64 exec, -1
    s_add_u32 s37, s37, 2048
    s_setprio 3
    s_waitcnt vmcnt(6)
    v_mfma_f32_32x32x16_bf16 v[16:31], v[104:107], v[96:99], 0
    s_nop 7
    s_nop 3
    v_exp_f32 v16, v16
    v_mfma_f32_32x32x16_bf16 v[32:47], v[104:107], v[100:103], 0
    buffer_load_dwordx4 v[116:119], v14, s[8:11], s36 offen sc1
    v_exp_f32 v17, v17
    v_exp_f32 v18, v18
    v_cvt_pk_bf16_f32 v48, v16, v17
    v_exp_f32 v19, v19
    v_exp_f32 v20, v20
    v_cvt_pk_bf16_f32 v49, v18, v19
    v_exp_f32 v21, v21
    s_add_u32 s36, s36, 2048
    v_exp_f32 v22, v22
    v_cvt_pk_bf16_f32 v50, v20, v21
    v_exp_f32 v23, v23
    v_exp_f32 v24, v24
    v_cvt_pk_bf16_f32 v51, v22, v23
    v_exp_f32 v25, v25
    v_exp_f32 v26, v26
    v_cvt_pk_bf16_f32 v52, v24, v25
    v_exp_f32 v27, v27
    v_exp_f32 v28, v28
    v_cvt_pk_bf16_f32 v53, v26, v27
    v_exp_f32 v29, v29
    v_exp_f32 v30, v30
    v_cvt_pk_bf16_f32 v54, v28, v29
    v_exp_f32 v31, v31
    v_exp_f32 v32, v32
    s_waitcnt vmcnt(4)
    v_cvt_pk_bf16_f32 v55, v30, v31
    v_mfma_f32_32x32x16_bf16 v[16:31], v[108:111], v[96:99], 0
    s_mov_b64 exec, s[40:41]
    buffer_load_dwordx4 v[136:139], v15, s[8:11], s37 offen sc1
    buffer_load_dwordx4 v[140:143], v15, s[8:11], s37 offen offset:512 sc1
    s_mov_b64 exec, -1
    v_exp_f32 v33, v33
    v_exp_f32 v34, v34
    v_cvt_pk_bf16_f32 v56, v32, v33
    v_exp_f32 v35, v35
    v_exp_f32 v36, v36
    v_cvt_pk_bf16_f32 v57, v34, v35
    v_exp_f32 v37, v37
    v_mfma_f32_32x32x16_bf16 v[64:79], v[120:123], v[48:51], v[64:79]
    s_add_u32 s37, s37, 2048
    v_exp_f32 v38, v38
    v_cvt_pk_bf16_f32 v58, v36, v37
    v_exp_f32 v39, v39
    v_exp_f32 v40, v40
    v_cvt_pk_bf16_f32 v59, v38, v39
    v_exp_f32 v41, v41
    v_exp_f32 v42, v42
    v_cvt_pk_bf16_f32 v60, v40, v41
    v_mfma_f32_32x32x16_bf16 v[64:79], v[124:127], v[52:55], v[64:79]
    v_exp_f32 v43, v43
    v_exp_f32 v44, v44
    v_cvt_pk_bf16_f32 v61, v42, v43
    v_exp_f32 v45, v45
    v_exp_f32 v46, v46
    v_cvt_pk_bf16_f32 v62, v44, v45
    v_exp_f32 v47, v47
    v_exp_f32 v16, v16
    v_cvt_pk_bf16_f32 v63, v46, v47
    v_mfma_f32_32x32x16_bf16 v[32:47], v[108:111], v[100:103], 0
    buffer_load_dwordx4 v[104:107], v14, s[8:11], s36 offen sc1
    v_exp_f32 v17, v17
    v_exp_f32 v18, v18
    v_cvt_pk_bf16_f32 v48, v16, v17
    v_exp_f32 v19, v19
    v_exp_f32 v20, v20
    v_cvt_pk_bf16_f32 v49, v18, v19
    v_exp_f32 v21, v21
    v_mfma_f32_32x32x16_bf16 v[80:95], v[120:123], v[56:59], v[80:95]
    s_add_u32 s36, s36, 2048
    v_exp_f32 v22, v22
    v_cvt_pk_bf16_f32 v50, v20, v21
    v_exp_f32 v23, v23
    v_exp_f32 v24, v24
    v_cvt_pk_bf16_f32 v51, v22, v23
    v_exp_f32 v25, v25
    v_exp_f32 v26, v26
    v_cvt_pk_bf16_f32 v52, v24, v25
    v_mfma_f32_32x32x16_bf16 v[80:95], v[124:127], v[60:63], v[80:95]
    v_exp_f32 v27, v27
    v_exp_f32 v28, v28
    v_cvt_pk_bf16_f32 v53, v26, v27
    v_exp_f32 v29, v29
    v_exp_f32 v30, v30
    v_cvt_pk_bf16_f32 v54, v28, v29
    v_exp_f32 v31, v31
    v_exp_f32 v32, v32
    s_waitcnt vmcnt(4)
    v_cvt_pk_bf16_f32 v55, v30, v31
    v_mfma_f32_32x32x16_bf16 v[16:31], v[112:115], v[96:99], 0
    s_mov_b64 exec, s[40:41]
    buffer_load_dwordx4 v[144:147], v15, s[8:11], s37 offen sc1
    buffer_load_dwordx4 v[148:151], v15, s[8:11], s37 offen offset:512 sc1
    s_mov_b64 exec, -1
    v_exp_f32 v33, v33
    v_exp_f32 v34, v34
    v_cvt_pk_bf16_f32 v56, v32, v33
    v_exp_f32 v35, v35
    v_exp_f32 v36, v36
    v_cvt_pk_bf16_f32 v57, v34, v35
    v_exp_f32 v37, v37
    v_mfma_f32_32x32x16_bf16 v[64:79], v[128:131], v[48:51], v[64:79]
    s_add_u32 s37, s37, 2048
    v_exp_f32 v38, v38
    v_cvt_pk_bf16_f32 v58, v36, v37
    v_exp_f32 v39, v39
    v_exp_f32 v40, v40
    v_cvt_pk_bf16_f32 v59, v38, v39
    v_exp_f32 v41, v41
    v_exp_f32 v42, v42
    v_cvt_pk_bf16_f32 v60, v40, v41
    v_mfma_f32_32x32x16_bf16 v[64:79], v[132:135], v[52:55], v[64:79]
    v_exp_f32 v43, v43
    v_exp_f32 v44, v44
    v_cvt_pk_bf16_f32 v61, v42, v43
    v_exp_f32 v45, v45
    v_exp_f32 v46, v46
    v_cvt_pk_bf16_f32 v62, v44, v45
    v_exp_f32 v47, v47
    v_mov_b32 v3, 1
    s_mov_b64 exec, 1
    ds_add_rtn_u32 v3, v12, v3 offset:116
    v_mov_b32 v2, 0
    s_waitcnt lgkmcnt(0)
    v_readfirstlane_b32 s66, v3
    v_mov_b32 v3, s7
    s_cmp_eq_u32 s66, 7
    s_cbranch_scc0 L_np31
    buffer_store_dword v3, v2, s[8:11], s55 offen sc1
L_np31:
    s_mov_b64 exec, -1
    v_exp_f32 v16, v16
    v_cvt_pk_bf16_f32 v63, v46, v47
    v_mfma_f32_32x32x16_bf16 v[32:47], v[112:115], v[100:103], 0
    buffer_load_dwordx4 v[108:111], v14, s[8:11], s36 offen sc1
    v_exp_f32 v17, v17
    v_exp_f32 v18, v18
    v_cvt_pk_bf16_f32 v48, v16, v17
    v_exp_f32 v19, v19
    v_exp_f32 v20, v20
    v_cvt_pk_bf16_f32 v49, v18, v19
    v_exp_f32 v21, v21
    v_mfma_f32_32x32x16_bf16 v[80:95], v[128:131], v[56:59], v[80:95]
    s_add_u32 s36, s36, 2048
    v_exp_f32 v22, v22
    v_cvt_pk_bf16_f32 v50, v20, v21
    v_exp_f32 v23, v23
    v_exp_f32 v24, v24
    v_cvt_pk_bf16_f32 v51, v22, v23
    v_exp_f32 v25, v25
    v_exp_f32 v26, v26
    v_cvt_pk_bf16_f32 v52, v24, v25
    v_mfma_f32_32x32x16_bf16 v[80:95], v[132:135], v[60:63], v[80:95]
    v_exp_f32 v27, v27
    v_exp_f32 v28, v28
    v_cvt_pk_bf16_f32 v53, v26, v27
    v_exp_f32 v29, v29
    v_exp_f32 v30, v30
    v_cvt_pk_bf16_f32 v54, v28, v29
    v_exp_f32 v31, v31
    v_exp_f32 v32, v32
    s_waitcnt vmcnt(4)
    v_cvt_pk_bf16_f32 v55, v30, v31
    v_mfma_f32_32x32x16_bf16 v[16:31], v[116:119], v[96:99], 0
    s_mov_b64 exec, s[40:41]
    buffer_load_dwordx4 v[120:123], v15, s[8:11], s37 offen sc1
    buffer_load_dwordx4 v[124:127], v15, s[8:11], s37 offen offset:512 sc1
    s_mov_b64 exec, -1
    v_exp_f32 v33, v33
    v_exp_f32 v34, v34
    v_cvt_pk_bf16_f32 v56, v32, v33
    v_exp_f32 v35, v35
    v_exp_f32 v36, v36
    v_cvt_pk_bf16_f32 v57, v34, v35
    v_exp_f32 v37, v37
    v_mfma_f32_32x32x16_bf16 v[64:79], v[136:139], v[48:51], v[64:79]
    s_add_u32 s37, s37, 2048
    v_exp_f32 v38, v38
    v_cvt_pk_bf16_f32 v58, v36, v37
    v_exp_f32 v39, v39
    v_exp_f32 v40, v40
    v_cvt_pk_bf16_f32 v59, v38, v39
    v_exp_f32 v41, v41
    v_exp_f32 v42, v42
    v_cvt_pk_bf16_f32 v60, v40, v41
    v_mfma_f32_32x32x16_bf16 v[64:79], v[140:143], v[52:55], v[64:79]
    v_exp_f32 v43, v43
    v_exp_f32 v44, v44
    v_cvt_pk_bf16_f32 v61, v42, v43
    v_exp_f32 v45, v45
    v_exp_f32 v46, v46
    v_cvt_pk_bf16_f32 v62, v44, v45
    v_exp_f32 v47, v47
    v_exp_f32 v16, v16
    v_cvt_pk_bf16_f32 v63, v46, v47
    v_mfma_f32_32x32x16_bf16 v[32:47], v[116:119], v[100:103], 0
    buffer_load_dwordx4 v[112:115], v14, s[8:11], s36 offen sc1
    v_exp_f32 v17, v17
    v_exp_f32 v18, v18
    v_cvt_pk_bf16_f32 v48, v16, v17
    v_exp_f32 v19, v19
    v_exp_f32 v20, v20
    v_cvt_pk_bf16_f32 v49, v18, v19
    v_exp_f32 v21, v21
    v_mfma_f32_32x32x16_bf16 v[80:95], v[136:139], v[56:59], v[80:95]
    s_add_u32 s36, s36, 2048
    v_exp_f32 v22, v22
    v_cvt_pk_bf16_f32 v50, v20, v21
    v_exp_f32 v23, v23
    v_exp_f32 v24, v24
    v_cvt_pk_bf16_f32 v51, v22, v23
    v_exp_f32 v25, v25
    v_exp_f32 v26, v26
    v_cvt_pk_bf16_f32 v52, v24, v25
    v_mfma_f32_32x32x16_bf16 v[80:95], v[140:143], v[60:63], v[80:95]
    v_exp_f32 v27, v27
    v_exp_f32 v28, v28
    v_cvt_pk_bf16_f32 v53, v26, v27
    v_exp_f32 v29, v29
    v_exp_f32 v30, v30
    v_cvt_pk_bf16_f32 v54, v28, v29
    v_exp_f32 v31, v31
    v_exp_f32 v32, v32
    s_waitcnt vmcnt(4)
    v_cvt_pk_bf16_f32 v55, v30, v31
    v_mfma_f32_32x32x16_bf16 v[16:31], v[104:107], v[96:99], 0
    s_mov_b64 exec, s[40:41]
    buffer_load_dwordx4 v[128:131], v15, s[8:11], s37 offen sc1
    buffer_load_dwordx4 v[132:135], v15, s[8:11], s37 offen offset:512 sc1
    s_mov_b64 exec, -1
    v_exp_f32 v33, v33
    v_exp_f32 v34, v34
    v_cvt_pk_bf16_f32 v56, v32, v33
    v_exp_f32 v35, v35
    v_exp_f32 v36, v36
    v_cvt_pk_bf16_f32 v57, v34, v35
    v_exp_f32 v37, v37
    v_mfma_f32_32x32x16_bf16 v[64:79], v[144:147], v[48:51], v[64:79]
    s_add_u32 s37, s37, 2048
    v_exp_f32 v38, v38
    v_cvt_pk_bf16_f32 v58, v36, v37
    v_exp_f32 v39, v39
    v_exp_f32 v40, v40
    v_cvt_pk_bf16_f32 v59, v38, v39
    v_exp_f32 v41, v41
    v_exp_f32 v42, v42
    v_cvt_pk_bf16_f32 v60, v40, v41
    v_mfma_f32_32x32x16_bf16 v[64:79], v[148:151], v[52:55], v[64:79]
    v_exp_f32 v43, v43
    v_exp_f32 v44, v44
    v_cvt_pk_bf16_f32 v61, v42, v43
    v_exp_f32 v45, v45
    v_exp_f32 v46, v46
    v_cvt_pk_bf16_f32 v62, v44, v45
    v_exp_f32 v47, v47
    v_exp_f32 v16, v16
    v_cvt_pk_bf16_f32 v63, v46, v47
    v_mfma_f32_32x32x16_bf16 v[32:47], v[104:107], v[100:103], 0
    buffer_load_dwordx4 v[116:119], v14, s[8:11], s36 offen sc1
    v_exp_f32 v17, v17
    v_exp_f32 v18, v18
    v_cvt_pk_bf16_f32 v48, v16, v17
    v_exp_f32 v19, v19
    v_exp_f32 v20, v20
    v_cvt_pk_bf16_f32 v49, v18, v19
    v_exp_f32 v21, v21
    v_mfma_f32_32x32x16_bf16 v[80:95], v[144:147], v[56:59], v[80:95]
    s_add_u32 s36, s36, 2048
    v_exp_f32 v22, v22
    v_cvt_pk_bf16_f32 v50, v20, v21
    v_exp_f32 v23, v23
    v_exp_f32 v24, v24
    v_cvt_pk_bf16_f32 v51, v22, v23
    v_exp_f32 v25, v25
    v_exp_f32 v26, v26
    v_cvt_pk_bf16_f32 v52, v24, v25
    v_mfma_f32_32x32x16_bf16 v[80:95], v[148:151], v[60:63], v[80:95]
    v_exp_f32 v27, v27
    v_exp_f32 v28, v28
    v_cvt_pk_bf16_f32 v53, v26, v27
    v_exp_f32 v29, v29
    v_exp_f32 v30, v30
    v_cvt_pk_bf16_f32 v54, v28, v29
    v_exp_f32 v31, v31
    v_exp_f32 v32, v32
    s_waitcnt vmcnt(4)
    v_cvt_pk_bf16_f32 v55, v30, v31
    v_mfma_f32_32x32x16_bf16 v[16:31], v[108:111], v[96:99], 0
    s_mov_b64 exec, s[40:41]
    buffer_load_dwordx4 v[136:139], v15, s[8:11], s37 offen sc1
    buffer_load_dwordx4 v[140:143], v15, s[8:11], s37 offen offset:512 sc1
    s_mov_b64 exec, -1
    v_exp_f32 v33, v33
    v_exp_f32 v34, v34
    v_cvt_pk_bf16_f32 v56, v32, v33
    v_exp_f32 v35, v35
    v_exp_f32 v36, v36
    v_cvt_pk_bf16_f32 v57, v34, v35
    v_exp_f32 v37, v37
    v_mfma_f32_32x32x16_bf16 v[64:79], v[120:123], v[48:51], v[64:79]
    s_add_u32 s37, s37, 2048
    v_exp_f32 v38, v38
    v_cvt_pk_bf16_f32 v58, v36, v37
    v_exp_f32 v39, v39
    v_exp_f32 v40, v40
    v_cvt_pk_bf16_f32 v59, v38, v39
    v_exp_f32 v41, v41
    v_exp_f32 v42, v42
    v_cvt_pk_bf16_f32 v60, v40, v41
    v_mfma_f32_32x32x16_bf16 v[64:79], v[124:127], v[52:55], v[64:79]
    v_exp_f32 v43, v43
    v_exp_f32 v44, v44
    v_cvt_pk_bf16_f32 v61, v42, v43
    v_exp_f32 v45, v45
    v_exp_f32 v46, v46
    v_cvt_pk_bf16_f32 v62, v44, v45
    v_exp_f32 v47, v47
    v_exp_f32 v16, v16
    v_cvt_pk_bf16_f32 v63, v46, v47
    v_mfma_f32_32x32x16_bf16 v[32:47], v[108:111], v[100:103], 0
    buffer_load_dwordx4 v[104:107], v14, s[8:11], s36 offen sc1
    v_exp_f32 v17, v17
    v_exp_f32 v18, v18
    v_cvt_pk_bf16_f32 v48, v16, v17
    v_exp_f32 v19, v19
    v_exp_f32 v20, v20
    v_cvt_pk_bf16_f32 v49, v18, v19
    v_exp_f32 v21, v21
    v_mfma_f32_32x32x16_bf16 v[80:95], v[120:123], v[56:59], v[80:95]
    s_add_u32 s36, s36, 2048
    v_exp_f32 v22, v22
    v_cvt_pk_bf16_f32 v50, v20, v21
    v_exp_f32 v23, v23
    v_exp_f32 v24, v24
    v_cvt_pk_bf16_f32 v51, v22, v23
    v_exp_f32 v25, v25
    v_exp_f32 v26, v26
    v_cvt_pk_bf16_f32 v52, v24, v25
    v_mfma_f32_32x32x16_bf16 v[80:95], v[124:127], v[60:63], v[80:95]
    v_exp_f32 v27, v27
    v_exp_f32 v28, v28
    v_cvt_pk_bf16_f32 v53, v26, v27
    v_exp_f32 v29, v29
    v_exp_f32 v30, v30
    v_cvt_pk_bf16_f32 v54, v28, v29
    v_exp_f32 v31, v31
    v_exp_f32 v32, v32
    s_waitcnt vmcnt(4)
    v_cvt_pk_bf16_f32 v55, v30, v31
    v_mfma_f32_32x32x16_bf16 v[16:31], v[112:115], v[96:99], 0
    s_mov_b64 exec, s[40:41]
    buffer_load_dwordx4 v[144:147], v15, s[8:11], s37 offen sc1
    buffer_load_dwordx4 v[148:151], v15, s[8:11], s37 offen offset:512 sc1
    s_mov_b64 exec, -1
    v_exp_f32 v33, v33
    v_exp_f32 v34, v34
    v_cvt_pk_bf16_f32 v56, v32, v33
    v_exp_f32 v35, v35
    v_exp_f32 v36, v36
    v_cvt_pk_bf16_f32 v57, v34, v35
    v_exp_f32 v37, v37
    v_mfma_f32_32x32x16_bf16 v[64:79], v[128:131], v[48:51], v[64:79]
    s_add_u32 s37, s37, 2048
    v_exp_f32 v38, v38
    v_cvt_pk_bf16_f32 v58, v36, v37
    v_exp_f32 v39, v39
    v_exp_f32 v40, v40
    v_cvt_pk_bf16_f32 v59, v38, v39
    v_exp_f32 v41, v41
    v_exp_f32 v42, v42
    v_cvt_pk_bf16_f32 v60, v40, v41
    v_mfma_f32_32x32x16_bf16 v[64:79], v[132:135], v[52:55], v[64:79]
    v_exp_f32 v43, v43
    v_exp_f32 v44, v44
    v_cvt_pk_bf16_f32 v61, v42, v43
    v_exp_f32 v45, v45
    v_exp_f32 v46, v46
    v_cvt_pk_bf16_f32 v62, v44, v45
    v_exp_f32 v47, v47
    v_exp_f32 v16, v16
    v_cvt_pk_bf16_f32 v63, v46, v47
    v_mfma_f32_32x32x16_bf16 v[32:47], v[112:115], v[100:103], 0
    buffer_load_dwordx4 v[108:111], v14, s[8:11], s36 offen sc1
    v_exp_f32 v17, v17
    v_exp_f32 v18, v18
    v_cvt_pk_bf16_f32 v48, v16, v17
    v_exp_f32 v19, v19
    v_exp_f32 v20, v20
    v_cvt_pk_bf16_f32 v49, v18, v19
    v_exp_f32 v21, v21
    v_mfma_f32_32x32x16_bf16 v[80:95], v[128:131], v[56:59], v[80:95]
    s_add_u32 s36, s36, 2048
    v_exp_f32 v22, v22
    v_cvt_pk_bf16_f32 v50, v20, v21
    v_exp_f32 v23, v23
    v_exp_f32 v24, v24
    v_cvt_pk_bf16_f32 v51, v22, v23
    v_exp_f32 v25, v25
    v_exp_f32 v26, v26
    v_cvt_pk_bf16_f32 v52, v24, v25
    v_mfma_f32_32x32x16_bf16 v[80:95], v[132:135], v[60:63], v[80:95]
    v_exp_f32 v27, v27
    v_exp_f32 v28, v28
    v_cvt_pk_bf16_f32 v53, v26, v27
    v_exp_f32 v29, v29
    v_exp_f32 v30, v30
    v_cvt_pk_bf16_f32 v54, v28, v29
    v_exp_f32 v31, v31
    v_exp_f32 v32, v32
    s_waitcnt vmcnt(4)
    v_cvt_pk_bf16_f32 v55, v30, v31
    v_mfma_f32_32x32x16_bf16 v[16:31], v[116:119], v[96:99], 0
    s_mov_b64 exec, s[40:41]
    buffer_load_dwordx4 v[120:123], v15, s[8:11], s37 offen sc1
    buffer_load_dwordx4 v[124:127], v15, s[8:11], s37 offen offset:512 sc1
    s_mov_b64 exec, -1
    v_exp_f32 v33, v33
    v_exp_f32 v34, v34
    v_cvt_pk_bf16_f32 v56, v32, v33
    v_exp_f32 v35, v35
    v_exp_f32 v36, v36
    v_cvt_pk_bf16_f32 v57, v34, v35
    v_exp_f32 v37, v37
    v_mfma_f32_32x32x16_bf16 v[64:79], v[136:139], v[48:51], v[64:79]
    s_add_u32 s37, s37, 2048
    v_exp_f32 v38, v38
    v_cvt_pk_bf16_f32 v58, v36, v37
    v_exp_f32 v39, v39
    v_exp_f32 v40, v40
    v_cvt_pk_bf16_f32 v59, v38, v39
    v_exp_f32 v41, v41
    v_exp_f32 v42, v42
    v_cvt_pk_bf16_f32 v60, v40, v41
    v_mfma_f32_32x32x16_bf16 v[64:79], v[140:143], v[52:55], v[64:79]
    v_exp_f32 v43, v43
    v_exp_f32 v44, v44
    v_cvt_pk_bf16_f32 v61, v42, v43
    v_exp_f32 v45, v45
    v_exp_f32 v46, v46
    v_cvt_pk_bf16_f32 v62, v44, v45
    v_exp_f32 v47, v47
    v_exp_f32 v16, v16
    v_cvt_pk_bf16_f32 v63, v46, v47
    v_mfma_f32_32x32x16_bf16 v[32:47], v[116:119], v[100:103], 0
    buffer_load_dwordx4 v[112:115], v14, s[8:11], s36 offen sc1
    v_exp_f32 v17, v17
    v_exp_f32 v18, v18
    v_cvt_pk_bf16_f32 v48, v16, v17
    v_exp_f32 v19, v19
    v_exp_f32 v20, v20
    v_cvt_pk_bf16_f32 v49, v18, v19
    v_exp_f32 v21, v21
    v_mfma_f32_32x32x16_bf16 v[80:95], v[136:139], v[56:59], v[80:95]
    s_add_u32 s36, s36, 2048
    v_exp_f32 v22, v22
    v_cvt_pk_bf16_f32 v50, v20, v21
    v_exp_f32 v23, v23
    v_exp_f32 v24, v24
    v_cvt_pk_bf16_f32 v51, v22, v23
    v_exp_f32 v25, v25
    v_exp_f32 v26, v26
    v_cvt_pk_bf16_f32 v52, v24, v25
    v_mfma_f32_32x32x16_bf16 v[80:95], v[140:143], v[60:63], v[80:95]
    v_exp_f32 v27, v27
    v_exp_f32 v28, v28
    v_cvt_pk_bf16_f32 v53, v26, v27
    v_exp_f32 v29, v29
    v_exp_f32 v30, v30
    v_cvt_pk_bf16_f32 v54, v28, v29
    v_exp_f32 v31, v31
    v_exp_f32 v32, v32
    s_waitcnt vmcnt(4)
    v_cvt_pk_bf16_f32 v55, v30, v31
    v_mfma_f32_32x32x16_bf16 v[16:31], v[104:107], v[96:99], 0
    s_mov_b64 exec, s[40:41]
    buffer_load_dwordx4 v[128:131], v15, s[8:11], s37 offen sc1
    buffer_load_dwordx4 v[132:135], v15, s[8:11], s37 offen offset:512 sc1
    s_mov_b64 exec, -1
    v_exp_f32 v33, v33
    v_exp_f32 v34, v34
    v_cvt_pk_bf16_f32 v56, v32, v33
    v_exp_f32 v35, v35
    v_exp_f32 v36, v36
    v_cvt_pk_bf16_f32 v57, v34, v35
    v_exp_f32 v37, v37
    v_mfma_f32_32x32x16_bf16 v[64:79], v[144:147], v[48:51], v[64:79]
    s_add_u32 s37, s37, 2048
    v_exp_f32 v38, v38
    v_cvt_pk_bf16_f32 v58, v36, v37
    v_exp_f32 v39, v39
    v_exp_f32 v40, v40
    v_cvt_pk_bf16_f32 v59, v38, v39
    v_exp_f32 v41, v41
    v_exp_f32 v42, v42
    v_cvt_pk_bf16_f32 v60, v40, v41
    v_mfma_f32_32x32x16_bf16 v[64:79], v[148:151], v[52:55], v[64:79]
    s_setprio 2
    v_exp_f32 v43, v43
    v_exp_f32 v44, v44
    v_cvt_pk_bf16_f32 v61, v42, v43
    v_exp_f32 v45, v45
    v_exp_f32 v46, v46
    v_cvt_pk_bf16_f32 v62, v44, v45
    v_exp_f32 v47, v47
    v_exp_f32 v16, v16
    v_cvt_pk_bf16_f32 v63, v46, v47
    v_mfma_f32_32x32x16_bf16 v[32:47], v[104:107], v[100:103], 0
    buffer_load_dwordx4 v[116:119], v14, s[8:11], s36 offen sc1
    v_exp_f32 v17, v17
    v_exp_f32 v18, v18
    v_cvt_pk_bf16_f32 v48, v16, v17
    v_exp_f32 v19, v19
    v_exp_f32 v20, v20
    v_cvt_pk_bf16_f32 v49, v18, v19
    v_exp_f32 v21, v21
    v_mfma_f32_32x32x16_bf16 v[80:95], v[144:147], v[56:59], v[80:95]
    s_add_u32 s36, s36, 2048
    v_exp_f32 v22, v22
    v_cvt_pk_bf16_f32 v50, v20, v21
    v_exp_f32 v23, v23
    v_exp_f32 v24, v24
    v_cvt_pk_bf16_f32 v51, v22, v23
    v_exp_f32 v25, v25
    v_exp_f32 v26, v26
    v_cvt_pk_bf16_f32 v52, v24, v25
    v_mfma_f32_32x32x16_bf16 v[80:95], v[148:151], v[60:63], v[80:95]
    v_exp_f32 v27, v27
    v_exp_f32 v28, v28
    v_cvt_pk_bf16_f32 v53, v26, v27
    v_exp_f32 v29, v29
    v_exp_f32 v30, v30
    v_cvt_pk_bf16_f32 v54, v28, v29
    v_exp_f32 v31, v31
    v_exp_f32 v32, v32
    s_waitcnt vmcnt(4)
    v_cvt_pk_bf16_f32 v55, v30, v31
    v_mfma_f32_32x32x16_bf16 v[16:31], v[108:111], v[96:99], 0
    s_mov_b64 exec, s[40:41]
    buffer_load_dwordx4 v[136:139], v15, s[8:11], s37 offen sc1
    buffer_load_dwordx4 v[140:143], v15, s[8:11], s37 offen offset:512 sc1
    s_mov_b64 exec, -1
    v_exp_f32 v33, v33
    v_exp_f32 v34, v34
    v_cvt_pk_bf16_f32 v56, v32, v33
    v_exp_f32 v35, v35
    v_exp_f32 v36, v36
    v_cvt_pk_bf16_f32 v57, v34, v35
    v_exp_f32 v37, v37
    v_mfma_f32_32x32x16_bf16 v[64:79], v[120:123], v[48:51], v[64:79]
    s_add_u32 s37, s37, 2048
    v_exp_f32 v38, v38
    v_cvt_pk_bf16_f32 v58, v36, v37
    v_exp_f32 v39, v39
    v_exp_f32 v40, v40
    v_cvt_pk_bf16_f32 v59, v38, v39
    v_exp_f32 v41, v41
    v_exp_f32 v42, v42
    v_cvt_pk_bf16_f32 v60, v40, v41
    v_mfma_f32_32x32x16_bf16 v[64:79], v[124:127], v[52:55], v[64:79]
    v_exp_f32 v43, v43
    v_exp_f32 v44, v44
    v_cvt_pk_bf16_f32 v61, v42, v43
    v_exp_f32 v45, v45
    v_exp_f32 v46, v46
    v_cvt_pk_bf16_f32 v62, v44, v45
    v_exp_f32 v47, v47
    v_exp_f32 v16, v16
    v_cvt_pk_bf16_f32 v63, v46, v47
    v_mfma_f32_32x32x16_bf16 v[32:47], v[108:111], v[100:103], 0
    buffer_load_dwordx4 v[104:107], v14, s[8:11], s36 offen sc1
    v_exp_f32 v17, v17
    v_exp_f32 v18, v18
    v_cvt_pk_bf16_f32 v48, v16, v17
    v_exp_f32 v19, v19
    v_exp_f32 v20, v20
    v_cvt_pk_bf16_f32 v49, v18, v19
    v_exp_f32 v21, v21
    v_mfma_f32_32x32x16_bf16 v[80:95], v[120:123], v[56:59], v[80:95]
    s_add_u32 s36, s36, 2048
    v_exp_f32 v22, v22
    v_cvt_pk_bf16_f32 v50, v20, v21
    v_exp_f32 v23, v23
    v_exp_f32 v24, v24
    v_cvt_pk_bf16_f32 v51, v22, v23
    v_exp_f32 v25, v25
    v_exp_f32 v26, v26
    v_cvt_pk_bf16_f32 v52, v24, v25
    v_mfma_f32_32x32x16_bf16 v[80:95], v[124:127], v[60:63], v[80:95]
    v_exp_f32 v27, v27
    v_exp_f32 v28, v28
    v_cvt_pk_bf16_f32 v53, v26, v27
    v_exp_f32 v29, v29
    v_exp_f32 v30, v30
    v_cvt_pk_bf16_f32 v54, v28, v29
    v_exp_f32 v31, v31
    v_exp_f32 v32, v32
    s_waitcnt vmcnt(4)
    v_cvt_pk_bf16_f32 v55, v30, v31
    v_mfma_f32_32x32x16_bf16 v[16:31], v[112:115], v[96:99], 0
    s_mov_b64 exec, s[40:41]
    buffer_load_dwordx4 v[144:147], v15, s[8:11], s37 offen sc1
    buffer_load_dwordx4 v[148:151], v15, s[8:11], s37 offen offset:512 sc1
    s_mov_b64 exec, -1
    v_exp_f32 v33, v33
    v_exp_f32 v34, v34
    v_cvt_pk_bf16_f32 v56, v32, v33
    v_exp_f32 v35, v35
    v_exp_f32 v36, v36
    v_cvt_pk_bf16_f32 v57, v34, v35
    v_exp_f32 v37, v37
    v_mfma_f32_32x32x16_bf16 v[64:79], v[128:131], v[48:51], v[64:79]
    s_add_u32 s37, s37, 2048
    v_exp_f32 v38, v38
    v_cvt_pk_bf16_f32 v58, v36, v37
    v_exp_f32 v39, v39
    v_exp_f32 v40, v40
    v_cvt_pk_bf16_f32 v59, v38, v39
    v_exp_f32 v41, v41
    v_exp_f32 v42, v42
    v_cvt_pk_bf16_f32 v60, v40, v41
    v_mfma_f32_32x32x16_bf16 v[64:79], v[132:135], v[52:55], v[64:79]
    v_exp_f32 v43, v43
    v_exp_f32 v44, v44
    v_cvt_pk_bf16_f32 v61, v42, v43
    v_exp_f32 v45, v45
    v_exp_f32 v46, v46
    v_cvt_pk_bf16_f32 v62, v44, v45
    v_exp_f32 v47, v47
    v_exp_f32 v16, v16
    v_cvt_pk_bf16_f32 v63, v46, v47
    v_mfma_f32_32x32x16_bf16 v[32:47], v[112:115], v[100:103], 0
    buffer_load_dwordx4 v[108:111], v14, s[8:11], s36 offen sc1
    v_exp_f32 v17, v17
    v_exp_f32 v18, v18
    v_cvt_pk_bf16_f32 v48, v16, v17
    v_exp_f32 v19, v19
    v_exp_f32 v20, v20
    v_cvt_pk_bf16_f32 v49, v18, v19
    v_exp_f32 v21, v21
    v_mfma_f32_32x32x16_bf16 v[80:95], v[128:131], v[56:59], v[80:95]
    s_add_u32 s36, s36, 2048
    v_exp_f32 v22, v22
    v_cvt_pk_bf16_f32 v50, v20, v21
    v_exp_f32 v23, v23
    v_exp_f32 v24, v24
    v_cvt_pk_bf16_f32 v51, v22, v23
    v_exp_f32 v25, v25
    v_exp_f32 v26, v26
    v_cvt_pk_bf16_f32 v52, v24, v25
    v_mfma_f32_32x32x16_bf16 v[80:95], v[132:135], v[60:63], v[80:95]
    v_exp_f32 v27, v27
    v_exp_f32 v28, v28
    v_cvt_pk_bf16_f32 v53, v26, v27
    v_exp_f32 v29, v29
    v_exp_f32 v30, v30
    v_cvt_pk_bf16_f32 v54, v28, v29
    v_exp_f32 v31, v31
    v_exp_f32 v32, v32
    s_waitcnt vmcnt(4)
    v_cvt_pk_bf16_f32 v55, v30, v31
    v_mfma_f32_32x32x16_bf16 v[16:31], v[116:119], v[96:99], 0
    s_mov_b64 exec, s[40:41]
    buffer_load_dwordx4 v[120:123], v15, s[8:11], s37 offen sc1
    buffer_load_dwordx4 v[124:127], v15, s[8:11], s37 offen offset:512 sc1
    s_mov_b64 exec, -1
    v_exp_f32 v33, v33
    v_exp_f32 v34, v34
    v_cvt_pk_bf16_f32 v56, v32, v33
    v_exp_f32 v35, v35
    v_exp_f32 v36, v36
    v_cvt_pk_bf16_f32 v57, v34, v35
    v_exp_f32 v37, v37
    v_mfma_f32_32x32x16_bf16 v[64:79], v[136:139], v[48:51], v[64:79]
    s_add_u32 s37, s37, 2048
    v_exp_f32 v38, v38
    v_cvt_pk_bf16_f32 v58, v36, v37
    v_exp_f32 v39, v39
    v_exp_f32 v40, v40
    v_cvt_pk_bf16_f32 v59, v38, v39
    v_exp_f32 v41, v41
    v_exp_f32 v42, v42
    v_cvt_pk_bf16_f32 v60, v40, v41
    v_mfma_f32_32x32x16_bf16 v[64:79], v[140:143], v[52:55], v[64:79]
    v_exp_f32 v43, v43
    v_exp_f32 v44, v44
    v_cvt_pk_bf16_f32 v61, v42, v43
    v_exp_f32 v45, v45
    v_exp_f32 v46, v46
    v_cvt_pk_bf16_f32 v62, v44, v45
    v_exp_f32 v47, v47
    v_exp_f32 v16, v16
    v_cvt_pk_bf16_f32 v63, v46, v47
    v_mfma_f32_32x32x16_bf16 v[32:47], v[116:119], v[100:103], 0
    buffer_load_dwordx4 v[112:115], v14, s[8:11], s36 offen sc1
    v_exp_f32 v17, v17
    v_exp_f32 v18, v18
    v_cvt_pk_bf16_f32 v48, v16, v17
    v_exp_f32 v19, v19
    v_exp_f32 v20, v20
    v_cvt_pk_bf16_f32 v49, v18, v19
    v_exp_f32 v21, v21
    v_mfma_f32_32x32x16_bf16 v[80:95], v[136:139], v[56:59], v[80:95]
    s_add_u32 s36, s36, 2048
    v_exp_f32 v22, v22
    v_cvt_pk_bf16_f32 v50, v20, v21
    v_exp_f32 v23, v23
    v_exp_f32 v24, v24
    v_cvt_pk_bf16_f32 v51, v22, v23
    v_exp_f32 v25, v25
    v_exp_f32 v26, v26
    v_cvt_pk_bf16_f32 v52, v24, v25
    v_mfma_f32_32x32x16_bf16 v[80:95], v[140:143], v[60:63], v[80:95]
    v_exp_f32 v27, v27
    v_exp_f32 v28, v28
    v_cvt_pk_bf16_f32 v53, v26, v27
    v_exp_f32 v29, v29
    v_exp_f32 v30, v30
    v_cvt_pk_bf16_f32 v54, v28, v29
    v_exp_f32 v31, v31
    v_exp_f32 v32, v32
    s_waitcnt vmcnt(4)
    v_cvt_pk_bf16_f32 v55, v30, v31
    v_mfma_f32_32x32x16_bf16 v[16:31], v[104:107], v[96:99], 0
    s_mov_b64 exec, s[40:41]
    buffer_load_dwordx4 v[128:131], v15, s[8:11], s37 offen sc1
    buffer_load_dwordx4 v[132:135], v15, s[8:11], s37 offen offset:512 sc1
    s_mov_b64 exec, -1
    v_exp_f32 v33, v33
    v_exp_f32 v34, v34
    v_cvt_pk_bf16_f32 v56, v32, v33
    v_exp_f32 v35, v35
    v_exp_f32 v36, v36
    v_cvt_pk_bf16_f32 v57, v34, v35
    v_exp_f32 v37, v37
    v_mfma_f32_32x32x16_bf16 v[64:79], v[144:147], v[48:51], v[64:79]
    s_add_u32 s37, s37, 2048
    v_exp_f32 v38, v38
    v_cvt_pk_bf16_f32 v58, v36, v37
    v_exp_f32 v39, v39
    v_exp_f32 v40, v40
    v_cvt_pk_bf16_f32 v59, v38, v39
    v_exp_f32 v41, v41
    v_exp_f32 v42, v42
    v_cvt_pk_bf16_f32 v60, v40, v41
    v_mfma_f32_32x32x16_bf16 v[64:79], v[148:151], v[52:55], v[64:79]
    v_exp_f32 v43, v43
    v_exp_f32 v44, v44
    v_cvt_pk_bf16_f32 v61, v42, v43
    v_exp_f32 v45, v45
    v_exp_f32 v46, v46
    v_cvt_pk_bf16_f32 v62, v44, v45
    v_exp_f32 v47, v47
    v_exp_f32 v16, v16
    v_cvt_pk_bf16_f32 v63, v46, v47
    v_mfma_f32_32x32x16_bf16 v[32:47], v[104:107], v[100:103], 0
    buffer_load_dwordx4 v[116:119], v14, s[8:11], s36 offen sc1
    v_exp_f32 v17, v17
    v_exp_f32 v18, v18
    v_cvt_pk_bf16_f32 v48, v16, v17
    v_exp_f32 v19, v19
    v_exp_f32 v20, v20
    v_cvt_pk_bf16_f32 v49, v18, v19
    v_exp_f32 v21, v21
    v_mfma_f32_32x32x16_bf16 v[80:95], v[144:147], v[56:59], v[80:95]
    s_add_u32 s36, s36, 2048
    v_exp_f32 v22, v22
    v_cvt_pk_bf16_f32 v50, v20, v21
    v_exp_f32 v23, v23
    v_exp_f32 v24, v24
    v_cvt_pk_bf16_f32 v51, v22, v23
    v_exp_f32 v25, v25
    v_exp_f32 v26, v26
    v_cvt_pk_bf16_f32 v52, v24, v25
    v_mfma_f32_32x32x16_bf16 v[80:95], v[148:151], v[60:63], v[80:95]
    v_exp_f32 v27, v27
    v_exp_f32 v28, v28
    v_cvt_pk_bf16_f32 v53, v26, v27
    v_exp_f32 v29, v29
    v_exp_f32 v30, v30
    v_cvt_pk_bf16_f32 v54, v28, v29
    v_exp_f32 v31, v31
    v_exp_f32 v32, v32
    s_waitcnt vmcnt(4)
    v_cvt_pk_bf16_f32 v55, v30, v31
    v_mfma_f32_32x32x16_bf16 v[16:31], v[108:111], v[96:99], 0
    s_mov_b64 exec, s[40:41]
    buffer_load_dwordx4 v[136:139], v15, s[8:11], s37 offen sc1
    buffer_load_dwordx4 v[140:143], v15, s[8:11], s37 offen offset:512 sc1
    s_mov_b64 exec, -1
    v_exp_f32 v33, v33
    v_exp_f32 v34, v34
    v_cvt_pk_bf16_f32 v56, v32, v33
    v_exp_f32 v35, v35
    v_exp_f32 v36, v36
    v_cvt_pk_bf16_f32 v57, v34, v35
    v_exp_f32 v37, v37
    v_mfma_f32_32x32x16_bf16 v[64:79], v[120:123], v[48:51], v[64:79]
    s_add_u32 s37, s37, 2048
    v_exp_f32 v38, v38
    v_cvt_pk_bf16_f32 v58, v36, v37
    v_exp_f32 v39, v39
    v_exp_f32 v40, v40
    v_cvt_pk_bf16_f32 v59, v38, v39
    v_exp_f32 v41, v41
    v_exp_f32 v42, v42
    v_cvt_pk_bf16_f32 v60, v40, v41
    v_mfma_f32_32x32x16_bf16 v[64:79], v[124:127], v[52:55], v[64:79]
    v_exp_f32 v43, v43
    v_exp_f32 v44, v44
    v_cvt_pk_bf16_f32 v61, v42, v43
    v_exp_f32 v45, v45
    v_exp_f32 v46, v46
    v_cvt_pk_bf16_f32 v62, v44, v45
    v_exp_f32 v47, v47
    v_exp_f32 v16, v16
    v_cvt_pk_bf16_f32 v63, v46, v47
    v_mfma_f32_32x32x16_bf16 v[32:47], v[108:111], v[100:103], 0
    buffer_load_dwordx4 v[104:107], v14, s[8:11], s36 offen sc1
    v_exp_f32 v17, v17
    v_exp_f32 v18, v18
    v_cvt_pk_bf16_f32 v48, v16, v17
    v_exp_f32 v19, v19
    v_exp_f32 v20, v20
    v_cvt_pk_bf16_f32 v49, v18, v19
    v_exp_f32 v21, v21
    v_mfma_f32_32x32x16_bf16 v[80:95], v[120:123], v[56:59], v[80:95]
    s_add_u32 s36, s36, 2048
    v_exp_f32 v22, v22
    v_cvt_pk_bf16_f32 v50, v20, v21
    v_exp_f32 v23, v23
    v_exp_f32 v24, v24
    v_cvt_pk_bf16_f32 v51, v22, v23
    v_exp_f32 v25, v25
    v_exp_f32 v26, v26
    v_cvt_pk_bf16_f32 v52, v24, v25
    v_mfma_f32_32x32x16_bf16 v[80:95], v[124:127], v[60:63], v[80:95]
    v_exp_f32 v27, v27
    v_exp_f32 v28, v28
    v_cvt_pk_bf16_f32 v53, v26, v27
    v_exp_f32 v29, v29
    v_exp_f32 v30, v30
    v_cvt_pk_bf16_f32 v54, v28, v29
    v_exp_f32 v31, v31
    v_exp_f32 v32, v32
    s_waitcnt vmcnt(4)
    v_cvt_pk_bf16_f32 v55, v30, v31
    v_mfma_f32_32x32x16_bf16 v[16:31], v[112:115], v[96:99], 0
    s_mov_b64 exec, s[40:41]
    buffer_load_dwordx4 v[144:147], v15, s[8:11], s37 offen sc1
    buffer_load_dwordx4 v[148:151], v15, s[8:11], s37 offen offset:512 sc1
    s_mov_b64 exec, -1
    v_exp_f32 v33, v33
    v_exp_f32 v34, v34
    v_cvt_pk_bf16_f32 v56, v32, v33
    v_exp_f32 v35, v35
    v_exp_f32 v36, v36
    v_cvt_pk_bf16_f32 v57, v34, v35
    v_exp_f32 v37, v37
    v_mfma_f32_32x32x16_bf16 v[64:79], v[128:131], v[48:51], v[64:79]
    s_add_u32 s37, s37, 2048
    v_exp_f32 v38, v38
    v_cvt_pk_bf16_f32 v58, v36, v37
    v_exp_f32 v39, v39
    v_exp_f32 v40, v40
    v_cvt_pk_bf16_f32 v59, v38, v39
    v_exp_f32 v41, v41
    v_exp_f32 v42, v42
    v_cvt_pk_bf16_f32 v60, v40, v41
    v_mfma_f32_32x32x16_bf16 v[64:79], v[132:135], v[52:55], v[64:79]
    v_exp_f32 v43, v43
    v_exp_f32 v44, v44
    v_cvt_pk_bf16_f32 v61, v42, v43
    v_exp_f32 v45, v45
    v_exp_f32 v46, v46
    v_cvt_pk_bf16_f32 v62, v44, v45
    v_exp_f32 v47, v47
    v_exp_f32 v16, v16
    v_cvt_pk_bf16_f32 v63, v46, v47
    v_mfma_f32_32x32x16_bf16 v[32:47], v[112:115], v[100:103], 0
    buffer_load_dwordx4 v[108:111], v14, s[8:11], s36 offen sc1
    v_exp_f32 v17, v17
    v_exp_f32 v18, v18
    v_cvt_pk_bf16_f32 v48, v16, v17
    v_exp_f32 v19, v19
    v_exp_f32 v20, v20
    v_cvt_pk_bf16_f32 v49, v18, v19
    v_exp_f32 v21, v21
    v_mfma_f32_32x32x16_bf16 v[80:95], v[128:131], v[56:59], v[80:95]
    s_add_u32 s36, s36, 2048
    v_exp_f32 v22, v22
    v_cvt_pk_bf16_f32 v50, v20, v21
    v_exp_f32 v23, v23
    v_exp_f32 v24, v24
    v_cvt_pk_bf16_f32 v51, v22, v23
    v_exp_f32 v25, v25
    v_exp_f32 v26, v26
    v_cvt_pk_bf16_f32 v52, v24, v25
    v_mfma_f32_32x32x16_bf16 v[80:95], v[132:135], v[60:63], v[80:95]
    v_exp_f32 v27, v27
    v_exp_f32 v28, v28
    v_cvt_pk_bf16_f32 v53, v26, v27
    v_exp_f32 v29, v29
    v_exp_f32 v30, v30
    v_cvt_pk_bf16_f32 v54, v28, v29
    v_exp_f32 v31, v31
    v_exp_f32 v32, v32
    s_waitcnt vmcnt(4)
    v_cvt_pk_bf16_f32 v55, v30, v31
    v_mfma_f32_32x32x16_bf16 v[16:31], v[116:119], v[96:99], 0
    s_mov_b64 exec, s[40:41]
    buffer_load_dwordx4 v[120:123], v15, s[8:11], s37 offen sc1
    buffer_load_dwordx4 v[124:127], v15, s[8:11], s37 offen offset:512 sc1
    s_mov_b64 exec, -1
    v_exp_f32 v33, v33
    v_exp_f32 v34, v34
    v_cvt_pk_bf16_f32 v56, v32, v33
    v_exp_f32 v35, v35
    v_exp_f32 v36, v36
    v_cvt_pk_bf16_f32 v57, v34, v35
    v_exp_f32 v37, v37
    v_mfma_f32_32x32x16_bf16 v[64:79], v[136:139], v[48:51], v[64:79]
    s_add_u32 s37, s37, 2048
    v_exp_f32 v38, v38
    v_cvt_pk_bf16_f32 v58, v36, v37
    v_exp_f32 v39, v39
    v_exp_f32 v40, v40
    v_cvt_pk_bf16_f32 v59, v38, v39
    v_exp_f32 v41, v41
    v_exp_f32 v42, v42
    v_cvt_pk_bf16_f32 v60, v40, v41
    v_mfma_f32_32x32x16_bf16 v[64:79], v[140:143], v[52:55], v[64:79]
    v_exp_f32 v43, v43
    v_exp_f32 v44, v44
    v_cvt_pk_bf16_f32 v61, v42, v43
    v_exp_f32 v45, v45
    v_exp_f32 v46, v46
    v_cvt_pk_bf16_f32 v62, v44, v45
    v_exp_f32 v47, v47
    v_exp_f32 v16, v16
    v_cvt_pk_bf16_f32 v63, v46, v47
    v_mfma_f32_32x32x16_bf16 v[32:47], v[116:119], v[100:103], 0
    buffer_load_dwordx4 v[112:115], v14, s[8:11], s36 offen sc1
    v_exp_f32 v17, v17
    v_exp_f32 v18, v18
    v_cvt_pk_bf16_f32 v48, v16, v17
    v_exp_f32 v19, v19
    v_exp_f32 v20, v20
    v_cvt_pk_bf16_f32 v49, v18, v19
    v_exp_f32 v21, v21
    v_mfma_f32_32x32x16_bf16 v[80:95], v[136:139], v[56:59], v[80:95]
    s_add_u32 s36, s36, 2048
    v_exp_f32 v22, v22
    v_cvt_pk_bf16_f32 v50, v20, v21
    v_exp_f32 v23, v23
    v_exp_f32 v24, v24
    v_cvt_pk_bf16_f32 v51, v22, v23
    v_exp_f32 v25, v25
    v_exp_f32 v26, v26
    v_cvt_pk_bf16_f32 v52, v24, v25
    v_mfma_f32_32x32x16_bf16 v[80:95], v[140:143], v[60:63], v[80:95]
    v_exp_f32 v27, v27
    v_exp_f32 v28, v28
    v_cvt_pk_bf16_f32 v53, v26, v27
    v_exp_f32 v29, v29
    v_exp_f32 v30, v30
    v_cvt_pk_bf16_f32 v54, v28, v29
    v_exp_f32 v31, v31
    v_exp_f32 v32, v32
    s_waitcnt vmcnt(4)
    v_cvt_pk_bf16_f32 v55, v30, v31
    v_mfma_f32_32x32x16_bf16 v[16:31], v[104:107], v[96:99], 0
    s_mov_b64 exec, s[40:41]
    buffer_load_dwordx4 v[128:131], v15, s[8:11], s37 offen sc1
    buffer_load_dwordx4 v[132:135], v15, s[8:11], s37 offen offset:512 sc1
    s_mov_b64 exec, -1
    v_exp_f32 v33, v33
    v_exp_f32 v34, v34
    v_cvt_pk_bf16_f32 v56, v32, v33
    v_exp_f32 v35, v35
    v_exp_f32 v36, v36
    v_cvt_pk_bf16_f32 v57, v34, v35
    v_exp_f32 v37, v37
    v_mfma_f32_32x32x16_bf16 v[64:79], v[144:147], v[48:51], v[64:79]
    s_add_u32 s37, s37, 2048
    v_exp_f32 v38, v38
    v_cvt_pk_bf16_f32 v58, v36, v37
    v_exp_f32 v39, v39
    v_exp_f32 v40, v40
    v_cvt_pk_bf16_f32 v59, v38, v39
    v_exp_f32 v41, v41
    v_exp_f32 v42, v42
    v_cvt_pk_bf16_f32 v60, v40, v41
    v_mfma_f32_32x32x16_bf16 v[64:79], v[148:151], v[52:55], v[64:79]
    s_setprio 1
    v_exp_f32 v43, v43
    v_exp_f32 v44, v44
    v_cvt_pk_bf16_f32 v61, v42, v43
    v_exp_f32 v45, v45
    v_exp_f32 v46, v46
    v_cvt_pk_bf16_f32 v62, v44, v45
    v_exp_f32 v47, v47
    v_exp_f32 v16, v16
    v_cvt_pk_bf16_f32 v63, v46, v47
    v_mfma_f32_32x32x16_bf16 v[32:47], v[104:107], v[100:103], 0
    buffer_load_dwordx4 v[116:119], v14, s[8:11], s36 offen sc1
    v_exp_f32 v17, v17
    v_exp_f32 v18, v18
    v_cvt_pk_bf16_f32 v48, v16, v17
    v_exp_f32 v19, v19
    v_exp_f32 v20, v20
    v_cvt_pk_bf16_f32 v49, v18, v19
    v_exp_f32 v21, v21
    v_mfma_f32_32x32x16_bf16 v[80:95], v[144:147], v[56:59], v[80:95]
    s_add_u32 s36, s36, 2048
    v_exp_f32 v22, v22
    v_cvt_pk_bf16_f32 v50, v20, v21
    v_exp_f32 v23, v23
    v_exp_f32 v24, v24
    v_cvt_pk_bf16_f32 v51, v22, v23
    v_exp_f32 v25, v25
    v_exp_f32 v26, v26
    v_cvt_pk_bf16_f32 v52, v24, v25
    v_mfma_f32_32x32x16_bf16 v[80:95], v[148:151], v[60:63], v[80:95]
    v_exp_f32 v27, v27
    v_exp_f32 v28, v28
    v_cvt_pk_bf16_f32 v53, v26, v27
    v_exp_f32 v29, v29
    v_exp_f32 v30, v30
    v_cvt_pk_bf16_f32 v54, v28, v29
    v_exp_f32 v31, v31
    v_exp_f32 v32, v32
    s_waitcnt vmcnt(4)
    v_cvt_pk_bf16_f32 v55, v30, v31
    v_mfma_f32_32x32x16_bf16 v[16:31], v[108:111], v[96:99], 0
    s_mov_b64 exec, s[40:41]
    buffer_load_dwordx4 v[136:139], v15, s[8:11], s37 offen sc1
    buffer_load_dwordx4 v[140:143], v15, s[8:11], s37 offen offset:512 sc1
    s_mov_b64 exec, -1
    v_exp_f32 v33, v33
    v_exp_f32 v34, v34
    v_cvt_pk_bf16_f32 v56, v32, v33
    v_exp_f32 v35, v35
    v_exp_f32 v36, v36
    v_cvt_pk_bf16_f32 v57, v34, v35
    v_exp_f32 v37, v37
    v_mfma_f32_32x32x16_bf16 v[64:79], v[120:123], v[48:51], v[64:79]
    s_add_u32 s37, s37, 2048
    v_exp_f32 v38, v38
    v_cvt_pk_bf16_f32 v58, v36, v37
    v_exp_f32 v39, v39
    v_exp_f32 v40, v40
    v_cvt_pk_bf16_f32 v59, v38, v39
    v_exp_f32 v41, v41
    v_exp_f32 v42, v42
    v_cvt_pk_bf16_f32 v60, v40, v41
    v_mfma_f32_32x32x16_bf16 v[64:79], v[124:127], v[52:55], v[64:79]
    v_exp_f32 v43, v43
    v_exp_f32 v44, v44
    v_cvt_pk_bf16_f32 v61, v42, v43
    v_exp_f32 v45, v45
    v_exp_f32 v46, v46
    v_cvt_pk_bf16_f32 v62, v44, v45
    v_exp_f32 v47, v47
    v_exp_f32 v16, v16
    v_cvt_pk_bf16_f32 v63, v46, v47
    v_mfma_f32_32x32x16_bf16 v[32:47], v[108:111], v[100:103], 0
    buffer_load_dwordx4 v[104:107], v14, s[8:11], s36 offen sc1
    v_exp_f32 v17, v17
    v_exp_f32 v18, v18
    v_cvt_pk_bf16_f32 v48, v16, v17
    v_exp_f32 v19, v19
    v_exp_f32 v20, v20
    v_cvt_pk_bf16_f32 v49, v18, v19
    v_exp_f32 v21, v21
    v_mfma_f32_32x32x16_bf16 v[80:95], v[120:123], v[56:59], v[80:95]
    s_add_u32 s36, s36, 2048
    v_exp_f32 v22, v22
    v_cvt_pk_bf16_f32 v50, v20, v21
    v_exp_f32 v23, v23
    v_exp_f32 v24, v24
    v_cvt_pk_bf16_f32 v51, v22, v23
    v_exp_f32 v25, v25
    v_exp_f32 v26, v26
    v_cvt_pk_bf16_f32 v52, v24, v25
    v_mfma_f32_32x32x16_bf16 v[80:95], v[124:127], v[60:63], v[80:95]
    v_exp_f32 v27, v27
    v_exp_f32 v28, v28
    v_cvt_pk_bf16_f32 v53, v26, v27
    v_exp_f32 v29, v29
    v_exp_f32 v30, v30
    v_cvt_pk_bf16_f32 v54, v28, v29
    v_exp_f32 v31, v31
    v_exp_f32 v32, v32
    s_waitcnt vmcnt(4)
    v_cvt_pk_bf16_f32 v55, v30, v31
    v_mfma_f32_32x32x16_bf16 v[16:31], v[112:115], v[96:99], 0
    s_mov_b64 exec, s[40:41]
    buffer_load_dwordx4 v[144:147], v15, s[8:11], s37 offen sc1
    buffer_load_dwordx4 v[148:151], v15, s[8:11], s37 offen offset:512 sc1
    s_mov_b64 exec, -1
    v_exp_f32 v33, v33
    v_exp_f32 v34, v34
    v_cvt_pk_bf16_f32 v56, v32, v33
    v_exp_f32 v35, v35
    v_exp_f32 v36, v36
    v_cvt_pk_bf16_f32 v57, v34, v35
    v_exp_f32 v37, v37
    v_mfma_f32_32x32x16_bf16 v[64:79], v[128:131], v[48:51], v[64:79]
    s_add_u32 s37, s37, 2048
    v_exp_f32 v38, v38
    v_cvt_pk_bf16_f32 v58, v36, v37
    v_exp_f32 v39, v39
    v_exp_f32 v40, v40
    v_cvt_pk_bf16_f32 v59, v38, v39
    v_exp_f32 v41, v41
    v_exp_f32 v42, v42
    v_cvt_pk_bf16_f32 v60, v40, v41
    v_mfma_f32_32x32x16_bf16 v[64:79], v[132:135], v[52:55], v[64:79]
    v_exp_f32 v43, v43
    v_exp_f32 v44, v44
    v_cvt_pk_bf16_f32 v61, v42, v43
    v_exp_f32 v45, v45
    v_exp_f32 v46, v46
    v_cvt_pk_bf16_f32 v62, v44, v45
    v_exp_f32 v47, v47
    v_exp_f32 v16, v16
    v_cvt_pk_bf16_f32 v63, v46, v47
    v_mfma_f32_32x32x16_bf16 v[32:47], v[112:115], v[100:103], 0
    buffer_load_dwordx4 v[108:111], v14, s[8:11], s36 offen sc1
    v_exp_f32 v17, v17
    v_exp_f32 v18, v18
    v_cvt_pk_bf16_f32 v48, v16, v17
    v_exp_f32 v19, v19
    v_exp_f32 v20, v20
    v_cvt_pk_bf16_f32 v49, v18, v19
    v_exp_f32 v21, v21
    v_mfma_f32_32x32x16_bf16 v[80:95], v[128:131], v[56:59], v[80:95]
    s_add_u32 s36, s36, 2048
    v_exp_f32 v22, v22
    v_cvt_pk_bf16_f32 v50, v20, v21
    v_exp_f32 v23, v23
    v_exp_f32 v24, v24
    v_cvt_pk_bf16_f32 v51, v22, v23
    v_exp_f32 v25, v25
    v_exp_f32 v26, v26
    v_cvt_pk_bf16_f32 v52, v24, v25
    v_mfma_f32_32x32x16_bf16 v[80:95], v[132:135], v[60:63], v[80:95]
    v_exp_f32 v27, v27
    v_exp_f32 v28, v28
    v_cvt_pk_bf16_f32 v53, v26, v27
    v_exp_f32 v29, v29
    v_exp_f32 v30, v30
    v_cvt_pk_bf16_f32 v54, v28, v29
    v_exp_f32 v31, v31
    v_exp_f32 v32, v32
    s_waitcnt vmcnt(4)
    v_cvt_pk_bf16_f32 v55, v30, v31
    v_mfma_f32_32x32x16_bf16 v[16:31], v[116:119], v[96:99], 0
    s_mov_b64 exec, s[40:41]
    buffer_load_dwordx4 v[120:123], v15, s[8:11], s37 offen sc1
    buffer_load_dwordx4 v[124:127], v15, s[8:11], s37 offen offset:512 sc1
    s_mov_b64 exec, -1
    v_exp_f32 v33, v33
    v_exp_f32 v34, v34
    v_cvt_pk_bf16_f32 v56, v32, v33
    v_exp_f32 v35, v35
    v_exp_f32 v36, v36
    v_cvt_pk_bf16_f32 v57, v34, v35
    v_exp_f32 v37, v37
    v_mfma_f32_32x32x16_bf16 v[64:79], v[136:139], v[48:51], v[64:79]
    s_add_u32 s37, s37, 2048
    v_exp_f32 v38, v38
    v_cvt_pk_bf16_f32 v58, v36, v37
    v_exp_f32 v39, v39
    v_exp_f32 v40, v40
    v_cvt_pk_bf16_f32 v59, v38, v39
    v_exp_f32 v41, v41
    v_exp_f32 v42, v42
    v_cvt_pk_bf16_f32 v60, v40, v41
    v_mfma_f32_32x32x16_bf16 v[64:79], v[140:143], v[52:55], v[64:79]
    v_exp_f32 v43, v43
    v_exp_f32 v44, v44
    v_cvt_pk_bf16_f32 v61, v42, v43
    v_exp_f32 v45, v45
    v_exp_f32 v46, v46
    v_cvt_pk_bf16_f32 v62, v44, v45
    v_exp_f32 v47, v47
    v_exp_f32 v16, v16
    v_cvt_pk_bf16_f32 v63, v46, v47
    v_mfma_f32_32x32x16_bf16 v[32:47], v[116:119], v[100:103], 0
    buffer_load_dwordx4 v[112:115], v14, s[8:11], s36 offen sc1
    v_exp_f32 v17, v17
    v_exp_f32 v18, v18
    v_cvt_pk_bf16_f32 v48, v16, v17
    v_exp_f32 v19, v19
    v_exp_f32 v20, v20
    v_cvt_pk_bf16_f32 v49, v18, v19
    v_exp_f32 v21, v21
    v_mfma_f32_32x32x16_bf16 v[80:95], v[136:139], v[56:59], v[80:95]
    s_add_u32 s36, s36, 2048
    v_exp_f32 v22, v22
    v_cvt_pk_bf16_f32 v50, v20, v21
    v_exp_f32 v23, v23
    v_exp_f32 v24, v24
    v_cvt_pk_bf16_f32 v51, v22, v23
    v_exp_f32 v25, v25
    v_exp_f32 v26, v26
    v_cvt_pk_bf16_f32 v52, v24, v25
    v_mfma_f32_32x32x16_bf16 v[80:95], v[140:143], v[60:63], v[80:95]
    v_exp_f32 v27, v27
    v_exp_f32 v28, v28
    v_cvt_pk_bf16_f32 v53, v26, v27
    v_exp_f32 v29, v29
    v_exp_f32 v30, v30
    v_cvt_pk_bf16_f32 v54, v28, v29
    v_exp_f32 v31, v31
    v_exp_f32 v32, v32
    s_waitcnt vmcnt(4)
    v_cvt_pk_bf16_f32 v55, v30, v31
    v_mfma_f32_32x32x16_bf16 v[16:31], v[104:107], v[96:99], 0
    s_mov_b64 exec, s[40:41]
    buffer_load_dwordx4 v[128:131], v15, s[8:11], s37 offen sc1
    buffer_load_dwordx4 v[132:135], v15, s[8:11], s37 offen offset:512 sc1
    s_mov_b64 exec, -1
    v_exp_f32 v33, v33
    v_exp_f32 v34, v34
    v_cvt_pk_bf16_f32 v56, v32, v33
    v_exp_f32 v35, v35
    v_exp_f32 v36, v36
    v_cvt_pk_bf16_f32 v57, v34, v35
    v_exp_f32 v37, v37
    v_mfma_f32_32x32x16_bf16 v[64:79], v[144:147], v[48:51], v[64:79]
    s_add_u32 s37, s37, 2048
    v_exp_f32 v38, v38
    v_cvt_pk_bf16_f32 v58, v36, v37
    v_exp_f32 v39, v39
    v_exp_f32 v40, v40
    v_cvt_pk_bf16_f32 v59, v38, v39
    v_exp_f32 v41, v41
    v_exp_f32 v42, v42
    v_cvt_pk_bf16_f32 v60, v40, v41
    v_mfma_f32_32x32x16_bf16 v[64:79], v[148:151], v[52:55], v[64:79]
    v_exp_f32 v43, v43
    v_exp_f32 v44, v44
    v_cvt_pk_bf16_f32 v61, v42, v43
    v_exp_f32 v45, v45
    v_exp_f32 v46, v46
    v_cvt_pk_bf16_f32 v62, v44, v45
    v_exp_f32 v47, v47
    v_exp_f32 v16, v16
    v_cvt_pk_bf16_f32 v63, v46, v47
    v_mfma_f32_32x32x16_bf16 v[32:47], v[104:107], v[100:103], 0
    buffer_load_dwordx4 v[116:119], v14, s[8:11], s36 offen sc1
    v_exp_f32 v17, v17
    v_exp_f32 v18, v18
    v_cvt_pk_bf16_f32 v48, v16, v17
    v_exp_f32 v19, v19
    v_exp_f32 v20, v20
    v_cvt_pk_bf16_f32 v49, v18, v19
    v_exp_f32 v21, v21
    v_mfma_f32_32x32x16_bf16 v[80:95], v[144:147], v[56:59], v[80:95]
    s_add_u32 s36, s36, 2048
    v_exp_f32 v22, v22
    v_cvt_pk_bf16_f32 v50, v20, v21
    v_exp_f32 v23, v23
    v_exp_f32 v24, v24
    v_cvt_pk_bf16_f32 v51, v22, v23
    v_exp_f32 v25, v25
    v_exp_f32 v26, v26
    v_cvt_pk_bf16_f32 v52, v24, v25
    v_mfma_f32_32x32x16_bf16 v[80:95], v[148:151], v[60:63], v[80:95]
    v_exp_f32 v27, v27
    v_exp_f32 v28, v28
    v_cvt_pk_bf16_f32 v53, v26, v27
    v_exp_f32 v29, v29
    v_exp_f32 v30, v30
    v_cvt_pk_bf16_f32 v54, v28, v29
    v_exp_f32 v31, v31
    v_exp_f32 v32, v32
    s_waitcnt vmcnt(4)
    v_cvt_pk_bf16_f32 v55, v30, v31
    v_mfma_f32_32x32x16_bf16 v[16:31], v[108:111], v[96:99], 0
    s_mov_b64 exec, s[40:41]
    buffer_load_dwordx4 v[136:139], v15, s[8:11], s37 offen sc1
    buffer_load_dwordx4 v[140:143], v15, s[8:11], s37 offen offset:512 sc1
    s_mov_b64 exec, -1
    v_exp_f32 v33, v33
    v_exp_f32 v34, v34
    v_cvt_pk_bf16_f32 v56, v32, v33
    v_exp_f32 v35, v35
    v_exp_f32 v36, v36
    v_cvt_pk_bf16_f32 v57, v34, v35
    v_exp_f32 v37, v37
    v_mfma_f32_32x32x16_bf16 v[64:79], v[120:123], v[48:51], v[64:79]
    s_add_u32 s37, s37, 2048
    v_exp_f32 v38, v38
    v_cvt_pk_bf16_f32 v58, v36, v37
    v_exp_f32 v39, v39
    v_exp_f32 v40, v40
    v_cvt_pk_bf16_f32 v59, v38, v39
    v_exp_f32 v41, v41
    v_exp_f32 v42, v42
    v_cvt_pk_bf16_f32 v60, v40, v41
    v_mfma_f32_32x32x16_bf16 v[64:79], v[124:127], v[52:55], v[64:79]
    v_exp_f32 v43, v43
    v_exp_f32 v44, v44
    v_cvt_pk_bf16_f32 v61, v42, v43
    v_exp_f32 v45, v45
    v_exp_f32 v46, v46
    v_cvt_pk_bf16_f32 v62, v44, v45
    v_exp_f32 v47, v47
    v_exp_f32 v16, v16
    v_cvt_pk_bf16_f32 v63, v46, v47
    v_mfma_f32_32x32x16_bf16 v[32:47], v[108:111], v[100:103], 0
    buffer_load_dwordx4 v[104:107], v14, s[8:11], s36 offen sc1
    v_exp_f32 v17, v17
    v_exp_f32 v18, v18
    v_cvt_pk_bf16_f32 v48, v16, v17
    v_exp_f32 v19, v19
    v_exp_f32 v20, v20
    v_cvt_pk_bf16_f32 v49, v18, v19
    v_exp_f32 v21, v21
    v_mfma_f32_32x32x16_bf16 v[80:95], v[120:123], v[56:59], v[80:95]
    s_add_u32 s36, s36, 2048
    v_exp_f32 v22, v22
    v_cvt_pk_bf16_f32 v50, v20, v21
    v_exp_f32 v23, v23
    v_exp_f32 v24, v24
    v_cvt_pk_bf16_f32 v51, v22, v23
    v_exp_f32 v25, v25
    v_exp_f32 v26, v26
    v_cvt_pk_bf16_f32 v52, v24, v25
    v_mfma_f32_32x32x16_bf16 v[80:95], v[124:127], v[60:63], v[80:95]
    v_exp_f32 v27, v27
    v_exp_f32 v28, v28
    v_cvt_pk_bf16_f32 v53, v26, v27
    v_exp_f32 v29, v29
    v_exp_f32 v30, v30
    v_cvt_pk_bf16_f32 v54, v28, v29
    v_exp_f32 v31, v31
    v_exp_f32 v32, v32
    s_waitcnt vmcnt(4)
    v_cvt_pk_bf16_f32 v55, v30, v31
    v_mfma_f32_32x32x16_bf16 v[16:31], v[112:115], v[96:99], 0
    s_mov_b64 exec, s[40:41]
    buffer_load_dwordx4 v[144:147], v15, s[8:11], s37 offen sc1
    buffer_load_dwordx4 v[148:151], v15, s[8:11], s37 offen offset:512 sc1
    s_mov_b64 exec, -1
    v_exp_f32 v33, v33
    v_exp_f32 v34, v34
    v_cvt_pk_bf16_f32 v56, v32, v33
    v_exp_f32 v35, v35
    v_exp_f32 v36, v36
    v_cvt_pk_bf16_f32 v57, v34, v35
    v_exp_f32 v37, v37
    v_mfma_f32_32x32x16_bf16 v[64:79], v[128:131], v[48:51], v[64:79]
    s_add_u32 s37, s37, 2048
    v_exp_f32 v38, v38
    v_cvt_pk_bf16_f32 v58, v36, v37
    v_exp_f32 v39, v39
    v_exp_f32 v40, v40
    v_cvt_pk_bf16_f32 v59, v38, v39
    v_exp_f32 v41, v41
    v_exp_f32 v42, v42
    v_cvt_pk_bf16_f32 v60, v40, v41
    v_mfma_f32_32x32x16_bf16 v[64:79], v[132:135], v[52:55], v[64:79]
    v_exp_f32 v43, v43
    v_exp_f32 v44, v44
    v_cvt_pk_bf16_f32 v61, v42, v43
    v_exp_f32 v45, v45
    v_exp_f32 v46, v46
    v_cvt_pk_bf16_f32 v62, v44, v45
    v_exp_f32 v47, v47
    v_exp_f32 v16, v16
    v_cvt_pk_bf16_f32 v63, v46, v47
    v_mfma_f32_32x32x16_bf16 v[32:47], v[112:115], v[100:103], 0
    buffer_load_dwordx4 v[108:111], v14, s[8:11], s36 offen sc1
    v_exp_f32 v17, v17
    v_exp_f32 v18, v18
    v_cvt_pk_bf16_f32 v48, v16, v17
    v_exp_f32 v19, v19
    v_exp_f32 v20, v20
    v_cvt_pk_bf16_f32 v49, v18, v19
    v_exp_f32 v21, v21
    v_mfma_f32_32x32x16_bf16 v[80:95], v[128:131], v[56:59], v[80:95]
    s_add_u32 s36, s36, 2048
    v_exp_f32 v22, v22
    v_cvt_pk_bf16_f32 v50, v20, v21
    v_exp_f32 v23, v23
    v_exp_f32 v24, v24
    v_cvt_pk_bf16_f32 v51, v22, v23
    v_exp_f32 v25, v25
    v_exp_f32 v26, v26
    v_cvt_pk_bf16_f32 v52, v24, v25
    v_mfma_f32_32x32x16_bf16 v[80:95], v[132:135], v[60:63], v[80:95]
    v_exp_f32 v27, v27
    v_exp_f32 v28, v28
    v_cvt_pk_bf16_f32 v53, v26, v27
    v_exp_f32 v29, v29
    v_exp_f32 v30, v30
    v_cvt_pk_bf16_f32 v54, v28, v29
    v_exp_f32 v31, v31
    v_exp_f32 v32, v32
    s_waitcnt vmcnt(4)
    v_cvt_pk_bf16_f32 v55, v30, v31
    v_mfma_f32_32x32x16_bf16 v[16:31], v[116:119], v[96:99], 0
    s_mov_b64 exec, s[40:41]
    buffer_load_dwordx4 v[120:123], v15, s[8:11], s37 offen sc1
    buffer_load_dwordx4 v[124:127], v15, s[8:11], s37 offen offset:512 sc1
    s_mov_b64 exec, -1
    v_exp_f32 v33, v33
    v_exp_f32 v34, v34
    v_cvt_pk_bf16_f32 v56, v32, v33
    v_exp_f32 v35, v35
    v_exp_f32 v36, v36
    v_cvt_pk_bf16_f32 v57, v34, v35
    v_exp_f32 v37, v37
    v_mfma_f32_32x32x16_bf16 v[64:79], v[136:139], v[48:51], v[64:79]
    s_add_u32 s37, s37, 2048
    v_exp_f32 v38, v38
    v_cvt_pk_bf16_f32 v58, v36, v37
    v_exp_f32 v39, v39
    v_exp_f32 v40, v40
    v_cvt_pk_bf16_f32 v59, v38, v39
    v_exp_f32 v41, v41
    v_exp_f32 v42, v42
    v_cvt_pk_bf16_f32 v60, v40, v41
    v_mfma_f32_32x32x16_bf16 v[64:79], v[140:143], v[52:55], v[64:79]
    v_exp_f32 v43, v43
    v_exp_f32 v44, v44
    v_cvt_pk_bf16_f32 v61, v42, v43
    v_exp_f32 v45, v45
    v_exp_f32 v46, v46
    v_cvt_pk_bf16_f32 v62, v44, v45
    v_exp_f32 v47, v47
    v_exp_f32 v16, v16
    v_cvt_pk_bf16_f32 v63, v46, v47
    v_mfma_f32_32x32x16_bf16 v[32:47], v[116:119], v[100:103], 0
    buffer_load_dwordx4 v[112:115], v14, s[8:11], s36 offen sc1
    v_exp_f32 v17, v17
    v_exp_f32 v18, v18
    v_cvt_pk_bf16_f32 v48, v16, v17
    v_exp_f32 v19, v19
    v_exp_f32 v20, v20
    v_cvt_pk_bf16_f32 v49, v18, v19
    v_exp_f32 v21, v21
    v_mfma_f32_32x32x16_bf16 v[80:95], v[136:139], v[56:59], v[80:95]
    s_add_u32 s36, s36, 2048
    v_exp_f32 v22, v22
    v_cvt_pk_bf16_f32 v50, v20, v21
    v_exp_f32 v23, v23
    v_exp_f32 v24, v24
    v_cvt_pk_bf16_f32 v51, v22, v23
    v_exp_f32 v25, v25
    v_exp_f32 v26, v26
    v_cvt_pk_bf16_f32 v52, v24, v25
    v_mfma_f32_32x32x16_bf16 v[80:95], v[140:143], v[60:63], v[80:95]
    v_exp_f32 v27, v27
    v_exp_f32 v28, v28
    v_cvt_pk_bf16_f32 v53, v26, v27
    v_exp_f32 v29, v29
    v_exp_f32 v30, v30
    v_cvt_pk_bf16_f32 v54, v28, v29
    v_exp_f32 v31, v31
    v_exp_f32 v32, v32
    s_waitcnt vmcnt(4)
    v_cvt_pk_bf16_f32 v55, v30, v31
    v_mfma_f32_32x32x16_bf16 v[16:31], v[104:107], v[96:99], 0
    s_mov_b64 exec, s[40:41]
    buffer_load_dwordx4 v[128:131], v15, s[8:11], s37 offen sc1
    buffer_load_dwordx4 v[132:135], v15, s[8:11], s37 offen offset:512 sc1
    s_mov_b64 exec, -1
    v_exp_f32 v33, v33
    v_exp_f32 v34, v34
    v_cvt_pk_bf16_f32 v56, v32, v33
    v_exp_f32 v35, v35
    v_exp_f32 v36, v36
    v_cvt_pk_bf16_f32 v57, v34, v35
    v_exp_f32 v37, v37
    v_mfma_f32_32x32x16_bf16 v[64:79], v[144:147], v[48:51], v[64:79]
    s_add_u32 s37, s37, 2048
    v_exp_f32 v38, v38
    v_cvt_pk_bf16_f32 v58, v36, v37
    v_exp_f32 v39, v39
    v_exp_f32 v40, v40
    v_cvt_pk_bf16_f32 v59, v38, v39
    v_exp_f32 v41, v41
    v_exp_f32 v42, v42
    v_cvt_pk_bf16_f32 v60, v40, v41
    v_mfma_f32_32x32x16_bf16 v[64:79], v[148:151], v[52:55], v[64:79]
    s_setprio 0
    v_exp_f32 v43, v43
    v_exp_f32 v44, v44
    v_cvt_pk_bf16_f32 v61, v42, v43
    v_exp_f32 v45, v45
    v_exp_f32 v46, v46
    v_cvt_pk_bf16_f32 v62, v44, v45
    v_exp_f32 v47, v47
    v_exp_f32 v16, v16
    v_cvt_pk_bf16_f32 v63, v46, v47
    v_mfma_f32_32x32x16_bf16 v[32:47], v[104:107], v[100:103], 0
    buffer_load_dwordx4 v[116:119], v14, s[8:11], s36 offen sc1
    v_exp_f32 v17, v17
    v_exp_f32 v18, v18
    v_cvt_pk_bf16_f32 v48, v16, v17
    v_exp_f32 v19, v19
    v_exp_f32 v20, v20
    v_cvt_pk_bf16_f32 v49, v18, v19
    v_exp_f32 v21, v21
    v_mfma_f32_32x32x16_bf16 v[80:95], v[144:147], v[56:59], v[80:95]
    s_add_u32 s36, s36, 2048
    v_exp_f32 v22, v22
    v_cvt_pk_bf16_f32 v50, v20, v21
    v_exp_f32 v23, v23
    v_exp_f32 v24, v24
    v_cvt_pk_bf16_f32 v51, v22, v23
    v_exp_f32 v25, v25
    v_exp_f32 v26, v26
    v_cvt_pk_bf16_f32 v52, v24, v25
    v_mfma_f32_32x32x16_bf16 v[80:95], v[148:151], v[60:63], v[80:95]
    v_exp_f32 v27, v27
    v_exp_f32 v28, v28
    v_cvt_pk_bf16_f32 v53, v26, v27
    v_exp_f32 v29, v29
    v_exp_f32 v30, v30
    v_cvt_pk_bf16_f32 v54, v28, v29
    v_exp_f32 v31, v31
    v_exp_f32 v32, v32
    s_waitcnt vmcnt(4)
    v_cvt_pk_bf16_f32 v55, v30, v31
    v_mfma_f32_32x32x16_bf16 v[16:31], v[108:111], v[96:99], 0
    s_mov_b64 exec, s[40:41]
    buffer_load_dwordx4 v[136:139], v15, s[8:11], s37 offen sc1
    buffer_load_dwordx4 v[140:143], v15, s[8:11], s37 offen offset:512 sc1
    s_mov_b64 exec, -1
    v_exp_f32 v33, v33
    v_exp_f32 v34, v34
    v_cvt_pk_bf16_f32 v56, v32, v33
    v_exp_f32 v35, v35
    v_exp_f32 v36, v36
    v_cvt_pk_bf16_f32 v57, v34, v35
    v_exp_f32 v37, v37
    v_mfma_f32_32x32x16_bf16 v[64:79], v[120:123], v[48:51], v[64:79]
    s_add_u32 s37, s37, 2048
    v_exp_f32 v38, v38
    v_cvt_pk_bf16_f32 v58, v36, v37
    v_exp_f32 v39, v39
    v_exp_f32 v40, v40
    v_cvt_pk_bf16_f32 v59, v38, v39
    v_exp_f32 v41, v41
    v_exp_f32 v42, v42
    v_cvt_pk_bf16_f32 v60, v40, v41
    v_mfma_f32_32x32x16_bf16 v[64:79], v[124:127], v[52:55], v[64:79]
    v_exp_f32 v43, v43
    v_exp_f32 v44, v44
    v_cvt_pk_bf16_f32 v61, v42, v43
    v_exp_f32 v45, v45
    v_exp_f32 v46, v46
    v_cvt_pk_bf16_f32 v62, v44, v45
    v_exp_f32 v47, v47
    v_exp_f32 v16, v16
    v_cvt_pk_bf16_f32 v63, v46, v47
    v_mfma_f32_32x32x16_bf16 v[32:47], v[108:111], v[100:103], 0
    buffer_load_dwordx4 v[104:107], v14, s[8:11], s36 offen sc1
    v_exp_f32 v17, v17
    v_exp_f32 v18, v18
    v_cvt_pk_bf16_f32 v48, v16, v17
    v_exp_f32 v19, v19
    v_exp_f32 v20, v20
    v_cvt_pk_bf16_f32 v49, v18, v19
    v_exp_f32 v21, v21
    v_mfma_f32_32x32x16_bf16 v[80:95], v[120:123], v[56:59], v[80:95]
    s_add_u32 s36, s36, 2048
    v_exp_f32 v22, v22
    v_cvt_pk_bf16_f32 v50, v20, v21
    v_exp_f32 v23, v23
    v_exp_f32 v24, v24
    v_cvt_pk_bf16_f32 v51, v22, v23
    v_exp_f32 v25, v25
    v_exp_f32 v26, v26
    v_cvt_pk_bf16_f32 v52, v24, v25
    v_mfma_f32_32x32x16_bf16 v[80:95], v[124:127], v[60:63], v[80:95]
    v_exp_f32 v27, v27
    v_exp_f32 v28, v28
    v_cvt_pk_bf16_f32 v53, v26, v27
    v_exp_f32 v29, v29
    v_exp_f32 v30, v30
    v_cvt_pk_bf16_f32 v54, v28, v29
    v_exp_f32 v31, v31
    v_exp_f32 v32, v32
    s_waitcnt vmcnt(4)
    v_cvt_pk_bf16_f32 v55, v30, v31
    v_mfma_f32_32x32x16_bf16 v[16:31], v[112:115], v[96:99], 0
    s_mov_b64 exec, s[40:41]
    buffer_load_dwordx4 v[144:147], v15, s[8:11], s37 offen sc1
    buffer_load_dwordx4 v[148:151], v15, s[8:11], s37 offen offset:512 sc1
    s_mov_b64 exec, -1
    v_exp_f32 v33, v33
    v_exp_f32 v34, v34
    v_cvt_pk_bf16_f32 v56, v32, v33
    v_exp_f32 v35, v35
    v_exp_f32 v36, v36
    v_cvt_pk_bf16_f32 v57, v34, v35
    v_exp_f32 v37, v37
    v_mfma_f32_32x32x16_bf16 v[64:79], v[128:131], v[48:51], v[64:79]
    s_add_u32 s37, s37, 2048
    v_exp_f32 v38, v38
    v_cvt_pk_bf16_f32 v58, v36, v37
    v_exp_f32 v39, v39
    v_exp_f32 v40, v40
    v_cvt_pk_bf16_f32 v59, v38, v39
    v_exp_f32 v41, v41
    v_exp_f32 v42, v42
    v_cvt_pk_bf16_f32 v60, v40, v41
    v_mfma_f32_32x32x16_bf16 v[64:79], v[132:135], v[52:55], v[64:79]
    v_exp_f32 v43, v43
    v_exp_f32 v44, v44
    v_cvt_pk_bf16_f32 v61, v42, v43
    v_exp_f32 v45, v45
    v_exp_f32 v46, v46
    v_cvt_pk_bf16_f32 v62, v44, v45
    v_exp_f32 v47, v47
    v_exp_f32 v16, v16
    v_cvt_pk_bf16_f32 v63, v46, v47
    v_mfma_f32_32x32x16_bf16 v[32:47], v[112:115], v[100:103], 0
    buffer_load_dwordx4 v[108:111], v14, s[8:11], s36 offen sc1
    v_exp_f32 v17, v17
    v_exp_f32 v18, v18
    v_cvt_pk_bf16_f32 v48, v16, v17
    v_exp_f32 v19, v19
    v_exp_f32 v20, v20
    v_cvt_pk_bf16_f32 v49, v18, v19
    v_exp_f32 v21, v21
    v_mfma_f32_32x32x16_bf16 v[80:95], v[128:131], v[56:59], v[80:95]
    s_add_u32 s36, s36, 2048
    v_exp_f32 v22, v22
    v_cvt_pk_bf16_f32 v50, v20, v21
    v_exp_f32 v23, v23
    v_exp_f32 v24, v24
    v_cvt_pk_bf16_f32 v51, v22, v23
    v_exp_f32 v25, v25
    v_exp_f32 v26, v26
    v_cvt_pk_bf16_f32 v52, v24, v25
    v_mfma_f32_32x32x16_bf16 v[80:95], v[132:135], v[60:63], v[80:95]
    v_exp_f32 v27, v27
    v_exp_f32 v28, v28
    v_cvt_pk_bf16_f32 v53, v26, v27
    v_exp_f32 v29, v29
    v_exp_f32 v30, v30
    v_cvt_pk_bf16_f32 v54, v28, v29
    v_exp_f32 v31, v31
    v_exp_f32 v32, v32
    s_waitcnt vmcnt(4)
    v_cvt_pk_bf16_f32 v55, v30, v31
    v_mfma_f32_32x32x16_bf16 v[16:31], v[116:119], v[96:99], 0
    s_mov_b64 exec, s[40:41]
    buffer_load_dwordx4 v[120:123], v15, s[8:11], s37 offen sc1
    buffer_load_dwordx4 v[124:127], v15, s[8:11], s37 offen offset:512 sc1
    s_mov_b64 exec, -1
    v_exp_f32 v33, v33
    v_exp_f32 v34, v34
    v_cvt_pk_bf16_f32 v56, v32, v33
    v_exp_f32 v35, v35
    v_exp_f32 v36, v36
    v_cvt_pk_bf16_f32 v57, v34, v35
    v_exp_f32 v37, v37
    v_mfma_f32_32x32x16_bf16 v[64:79], v[136:139], v[48:51], v[64:79]
    s_add_u32 s37, s37, 2048
    v_exp_f32 v38, v38
    v_cvt_pk_bf16_f32 v58, v36, v37
    v_exp_f32 v39, v39
    v_exp_f32 v40, v40
    v_cvt_pk_bf16_f32 v59, v38, v39
    v_exp_f32 v41, v41
    v_exp_f32 v42, v42
    v_cvt_pk_bf16_f32 v60, v40, v41
    v_mfma_f32_32x32x16_bf16 v[64:79], v[140:143], v[52:55], v[64:79]
    v_exp_f32 v43, v43
    v_exp_f32 v44, v44
    v_cvt_pk_bf16_f32 v61, v42, v43
    v_exp_f32 v45, v45
    v_exp_f32 v46, v46
    v_cvt_pk_bf16_f32 v62, v44, v45
    v_exp_f32 v47, v47
    v_exp_f32 v16, v16
    v_cvt_pk_bf16_f32 v63, v46, v47
    v_mfma_f32_32x32x16_bf16 v[32:47], v[116:119], v[100:103], 0
    buffer_load_dwordx4 v[112:115], v14, s[8:11], s36 offen sc1
    v_exp_f32 v17, v17
    v_exp_f32 v18, v18
    v_cvt_pk_bf16_f32 v48, v16, v17
    v_exp_f32 v19, v19
    v_exp_f32 v20, v20
    v_cvt_pk_bf16_f32 v49, v18, v19
    v_exp_f32 v21, v21
    v_mfma_f32_32x32x16_bf16 v[80:95], v[136:139], v[56:59], v[80:95]
    s_add_u32 s36, s36, 2048
    v_exp_f32 v22, v22
    v_cvt_pk_bf16_f32 v50, v20, v21
    v_exp_f32 v23, v23
    v_exp_f32 v24, v24
    v_cvt_pk_bf16_f32 v51, v22, v23
    v_exp_f32 v25, v25
    v_exp_f32 v26, v26
    v_cvt_pk_bf16_f32 v52, v24, v25
    v_mfma_f32_32x32x16_bf16 v[80:95], v[140:143], v[60:63], v[80:95]
    v_exp_f32 v27, v27
    v_exp_f32 v28, v28
    v_cvt_pk_bf16_f32 v53, v26, v27
    v_exp_f32 v29, v29
    v_exp_f32 v30, v30
    v_cvt_pk_bf16_f32 v54, v28, v29
    v_exp_f32 v31, v31
    v_exp_f32 v32, v32
    s_waitcnt vmcnt(4)
    v_cvt_pk_bf16_f32 v55, v30, v31
    v_mfma_f32_32x32x16_bf16 v[16:31], v[104:107], v[96:99], 0
    s_mov_b64 exec, s[40:41]
    buffer_load_dwordx4 v[128:131], v15, s[8:11], s37 offen sc1
    buffer_load_dwordx4 v[132:135], v15, s[8:11], s37 offen offset:512 sc1
    s_mov_b64 exec, -1
    v_exp_f32 v33, v33
    v_exp_f32 v34, v34
    v_cvt_pk_bf16_f32 v56, v32, v33
    v_exp_f32 v35, v35
    v_exp_f32 v36, v36
    v_cvt_pk_bf16_f32 v57, v34, v35
    v_exp_f32 v37, v37
    v_mfma_f32_32x32x16_bf16 v[64:79], v[144:147], v[48:51], v[64:79]
    s_add_u32 s37, s37, 2048
    v_exp_f32 v38, v38
    v_cvt_pk_bf16_f32 v58, v36, v37
    v_exp_f32 v39, v39
    v_exp_f32 v40, v40
    v_cvt_pk_bf16_f32 v59, v38, v39
    v_exp_f32 v41, v41
    v_exp_f32 v42, v42
    v_cvt_pk_bf16_f32 v60, v40, v41
    v_mfma_f32_32x32x16_bf16 v[64:79], v[148:151], v[52:55], v[64:79]
    v_exp_f32 v43, v43
    v_exp_f32 v44, v44
    v_cvt_pk_bf16_f32 v61, v42, v43
    v_exp_f32 v45, v45
    v_exp_f32 v46, v46
    v_cvt_pk_bf16_f32 v62, v44, v45
    v_exp_f32 v47, v47
    v_exp_f32 v16, v16
    v_cvt_pk_bf16_f32 v63, v46, v47
    v_mfma_f32_32x32x16_bf16 v[32:47], v[104:107], v[100:103], 0
    buffer_load_dwordx4 v[116:119], v14, s[8:11], s36 offen sc1
    v_exp_f32 v17, v17
    v_exp_f32 v18, v18
    v_cvt_pk_bf16_f32 v48, v16, v17
    v_exp_f32 v19, v19
    v_exp_f32 v20, v20
    v_cvt_pk_bf16_f32 v49, v18, v19
    v_exp_f32 v21, v21
    v_mfma_f32_32x32x16_bf16 v[80:95], v[144:147], v[56:59], v[80:95]
    s_add_u32 s36, s36, 2048
    v_exp_f32 v22, v22
    v_cvt_pk_bf16_f32 v50, v20, v21
    v_exp_f32 v23, v23
    v_exp_f32 v24, v24
    v_cvt_pk_bf16_f32 v51, v22, v23
    v_exp_f32 v25, v25
    v_exp_f32 v26, v26
    v_cvt_pk_bf16_f32 v52, v24, v25
    v_mfma_f32_32x32x16_bf16 v[80:95], v[148:151], v[60:63], v[80:95]
    v_exp_f32 v27, v27
    v_exp_f32 v28, v28
    v_cvt_pk_bf16_f32 v53, v26, v27
    v_exp_f32 v29, v29
    v_exp_f32 v30, v30
    v_cvt_pk_bf16_f32 v54, v28, v29
    v_exp_f32 v31, v31
    v_exp_f32 v32, v32
    s_waitcnt vmcnt(4)
    v_cvt_pk_bf16_f32 v55, v30, v31
    v_mfma_f32_32x32x16_bf16 v[16:31], v[108:111], v[96:99], 0
    s_mov_b64 exec, s[40:41]
    buffer_load_dwordx4 v[136:139], v15, s[8:11], s37 offen sc1
    buffer_load_dwordx4 v[140:143], v15, s[8:11], s37 offen offset:512 sc1
    s_mov_b64 exec, -1
    v_exp_f32 v33, v33
    v_exp_f32 v34, v34
    v_cvt_pk_bf16_f32 v56, v32, v33
    v_exp_f32 v35, v35
    v_exp_f32 v36, v36
    v_cvt_pk_bf16_f32 v57, v34, v35
    v_exp_f32 v37, v37
    v_mfma_f32_32x32x16_bf16 v[64:79], v[120:123], v[48:51], v[64:79]
    s_add_u32 s37, s37, 2048
    v_exp_f32 v38, v38
    v_cvt_pk_bf16_f32 v58, v36, v37
    v_exp_f32 v39, v39
    v_exp_f32 v40, v40
    v_cvt_pk_bf16_f32 v59, v38, v39
    v_exp_f32 v41, v41
    v_exp_f32 v42, v42
    v_cvt_pk_bf16_f32 v60, v40, v41
    v_mfma_f32_32x32x16_bf16 v[64:79], v[124:127], v[52:55], v[64:79]
    v_exp_f32 v43, v43
    v_exp_f32 v44, v44
    v_cvt_pk_bf16_f32 v61, v42, v43
    v_exp_f32 v45, v45
    v_exp_f32 v46, v46
    v_cvt_pk_bf16_f32 v62, v44, v45
    v_exp_f32 v47, v47
    v_exp_f32 v16, v16
    v_cvt_pk_bf16_f32 v63, v46, v47
    v_mfma_f32_32x32x16_bf16 v[32:47], v[108:111], v[100:103], 0
    v_exp_f32 v17, v17
    v_exp_f32 v18, v18
    v_cvt_pk_bf16_f32 v48, v16, v17
    v_exp_f32 v19, v19
    v_exp_f32 v20, v20
    v_cvt_pk_bf16_f32 v49, v18, v19
    v_exp_f32 v21, v21
    v_mfma_f32_32x32x16_bf16 v[80:95], v[120:123], v[56:59], v[80:95]
    v_exp_f32 v22, v22
    v_cvt_pk_bf16_f32 v50, v20, v21
    v_exp_f32 v23, v23
    v_exp_f32 v24, v24
    v_cvt_pk_bf16_f32 v51, v22, v23
    v_exp_f32 v25, v25
    v_exp_f32 v26, v26
    v_cvt_pk_bf16_f32 v52, v24, v25
    v_mfma_f32_32x32x16_bf16 v[80:95], v[124:127], v[60:63], v[80:95]
    v_exp_f32 v27, v27
    v_exp_f32 v28, v28
    v_cvt_pk_bf16_f32 v53, v26, v27
    v_exp_f32 v29, v29
    v_exp_f32 v30, v30
    v_cvt_pk_bf16_f32 v54, v28, v29
    v_exp_f32 v31, v31
    v_exp_f32 v32, v32
    s_waitcnt vmcnt(3)
    v_cvt_pk_bf16_f32 v55, v30, v31
    v_mfma_f32_32x32x16_bf16 v[16:31], v[112:115], v[96:99], 0
    s_mov_b64 exec, s[40:41]
    buffer_load_dwordx4 v[144:147], v15, s[8:11], s37 offen sc1
    buffer_load_dwordx4 v[148:151], v15, s[8:11], s37 offen offset:512 sc1
    s_mov_b64 exec, -1
    v_exp_f32 v33, v33
    v_exp_f32 v34, v34
    v_cvt_pk_bf16_f32 v56, v32, v33
    v_exp_f32 v35, v35
    v_exp_f32 v36, v36
    v_cvt_pk_bf16_f32 v57, v34, v35
    v_exp_f32 v37, v37
    v_mfma_f32_32x32x16_bf16 v[64:79], v[128:131], v[48:51], v[64:79]
    s_add_u32 s37, s37, 2048
    v_exp_f32 v38, v38
    v_cvt_pk_bf16_f32 v58, v36, v37
    v_exp_f32 v39, v39
    v_exp_f32 v40, v40
    v_cvt_pk_bf16_f32 v59, v38, v39
    v_exp_f32 v41, v41
    v_exp_f32 v42, v42
    v_cvt_pk_bf16_f32 v60, v40, v41
    v_mfma_f32_32x32x16_bf16 v[64:79], v[132:135], v[52:55], v[64:79]
    v_exp_f32 v43, v43
    v_exp_f32 v44, v44
    v_cvt_pk_bf16_f32 v61, v42, v43
    v_exp_f32 v45, v45
    v_exp_f32 v46, v46
    v_cvt_pk_bf16_f32 v62, v44, v45
    v_exp_f32 v47, v47
    v_exp_f32 v16, v16
    v_cvt_pk_bf16_f32 v63, v46, v47
    v_mfma_f32_32x32x16_bf16 v[32:47], v[112:115], v[100:103], 0
    v_exp_f32 v17, v17
    v_exp_f32 v18, v18
    v_cvt_pk_bf16_f32 v48, v16, v17
    v_exp_f32 v19, v19
    v_exp_f32 v20, v20
    v_cvt_pk_bf16_f32 v49, v18, v19
    v_exp_f32 v21, v21
    v_mfma_f32_32x32x16_bf16 v[80:95], v[128:131], v[56:59], v[80:95]
    v_exp_f32 v22, v22
    v_cvt_pk_bf16_f32 v50, v20, v21
    v_exp_f32 v23, v23
    v_exp_f32 v24, v24
    v_cvt_pk_bf16_f32 v51, v22, v23
    v_exp_f32 v25, v25
    v_exp_f32 v26, v26
    v_cvt_pk_bf16_f32 v52, v24, v25
    v_mfma_f32_32x32x16_bf16 v[80:95], v[132:135], v[60:63], v[80:95]
    v_exp_f32 v27, v27
    v_exp_f32 v28, v28
    v_cvt_pk_bf16_f32 v53, v26, v27
    v_exp_f32 v29, v29
    v_exp_f32 v30, v30
    v_cvt_pk_bf16_f32 v54, v28, v29
    v_exp_f32 v31, v31
    v_exp_f32 v32, v32
    s_waitcnt vmcnt(2)
    v_cvt_pk_bf16_f32 v55, v30, v31
    v_mfma_f32_32x32x16_bf16 v[16:31], v[116:119], v[96:99], 0
    v_exp_f32 v33, v33
    v_exp_f32 v34, v34
    v_cvt_pk_bf16_f32 v56, v32, v33
    v_exp_f32 v35, v35
    v_exp_f32 v36, v36
    v_cvt_pk_bf16_f32 v57, v34, v35
    v_exp_f32 v37, v37
    v_mfma_f32_32x32x16_bf16 v[64:79], v[136:139], v[48:51], v[64:79]
    v_exp_f32 v38, v38
    v_cvt_pk_bf16_f32 v58, v36, v37
    v_exp_f32 v39, v39
    v_exp_f32 v40, v40
    v_cvt_pk_bf16_f32 v59, v38, v39
    v_exp_f32 v41, v41
    v_exp_f32 v42, v42
    v_cvt_pk_bf16_f32 v60, v40, v41
    v_mfma_f32_32x32x16_bf16 v[64:79], v[140:143], v[52:55], v[64:79]
    s_mov_b64 exec, 1
    ds_add_u32 v12, v12 offset:88
    s_mov_b64 exec, -1
    v_exp_f32 v43, v43
    v_exp_f32 v44, v44
    v_cvt_pk_bf16_f32 v61, v42, v43
    v_exp_f32 v45, v45
    v_exp_f32 v46, v46
    v_cvt_pk_bf16_f32 v62, v44, v45
    v_exp_f32 v47, v47
    s_and_b32 s26, s3, 3
    s_xor_b32 s27, s26, 2
    s_mul_i32 s26, s26, 2304
    s_add_u32 s26, s26, 65536
    s_mul_i32 s27, s27, 2304
    s_add_u32 s27, s27, 65536
    v_add_u32 v6, s26, v5
    v_add_u32 v7, s27, v5
    v_lshlrev_b32 v8, 2, v4
    v_add_u32 v9, s27, v8
    v_add_u32 v8, s26, v8
    s_sub_u32 s26, s3, 4
    s_lshl_b32 s26, s26, 2
    v_add_u32 v10, s26, v12
    s_xor_b32 s26, s26, 8
    v_add_u32 v11, s26, v12
    s_cmp_eq_u32 s19, 0
    s_cbranch_scc0 L_xa
    s_mov_b32 s66, 0
L_sp32:
    ds_read_b32 v3, v12 offset:116
    s_add_u32 s66, s66, 1
    s_waitcnt lgkmcnt(0)
    v_readfirstlane_b32 s67, v3
    s_cmp_ge_u32 s66, 524288
    s_cbranch_scc1 L_se33
    s_cmp_ge_u32 s67, 8
    s_cbranch_scc1 L_se33
    s_sleep 1
    s_branch L_sp32
L_se33:
    s_branch L_xb
L_xa:
    s_mov_b32 s66, 0
L_sp34:
    ds_read_b32 v3, v12 offset:16
    s_add_u32 s66, s66, 1
    s_waitcnt lgkmcnt(0)
    v_readfirstlane_b32 s67, v3
    s_cmp_ge_u32 s66, 524288
    s_cbranch_scc1 L_se35
    s_cmp_ge_u32 s67, 4
    s_cbranch_scc1 L_se35
    s_sleep 1
    s_branch L_sp34
L_se35:
L_xb:
    s_mov_b32 s44, 0x1f800000
    s_mov_b32 s45, 0x5f800000
    s_mov_b32 s46, 0x7f7fffff
    s_lshl_b32 s26, s19, 2
    v_add_u32 v13, s26, v12
    v_mov_b32 v3, 1
    buffer_load_dword v1, v163, s[8:11], s52 offen sc1
    v_exp_f32 v16, v16
    v_cvt_pk_bf16_f32 v63, v46, v47
    v_mfma_f32_32x32x16_bf16 v[32:47], v[116:119], v[100:103], 0
    v_exp_f32 v17, v17
    v_exp_f32 v18, v18
    v_cvt_pk_bf16_f32 v48, v16, v17
    v_exp_f32 v19, v19
    v_exp_f32 v20, v20
    v_cvt_pk_bf16_f32 v49, v18, v19
    v_exp_f32 v21, v21
    v_mfma_f32_32x32x16_bf16 v[80:95], v[136:139], v[56:59], v[80:95]
    v_exp_f32 v22, v22
    v_cvt_pk_bf16_f32 v50, v20, v21
    v_exp_f32 v23, v23
    v_exp_f32 v24, v24
    v_cvt_pk_bf16_f32 v51, v22, v23
    v_exp_f32 v25, v25
    v_exp_f32 v26, v26
    v_cvt_pk_bf16_f32 v52, v24, v25
    v_mfma_f32_32x32x16_bf16 v[80:95], v[140:143], v[60:63], v[80:95]
    v_exp_f32 v27, v27
    v_exp_f32 v28, v28
    v_cvt_pk_bf16_f32 v53, v26, v27
    v_exp_f32 v29, v29
    v_exp_f32 v30, v30
    v_cvt_pk_bf16_f32 v54, v28, v29
    v_exp_f32 v31, v31
    v_exp_f32 v32, v32
    s_waitcnt vmcnt(1)
    v_cvt_pk_bf16_f32 v55, v30, v31
    v_exp_f32 v33, v33
    v_exp_f32 v34, v34
    v_cvt_pk_bf16_f32 v56, v32, v33
    v_exp_f32 v35, v35
    v_exp_f32 v36, v36
    v_cvt_pk_bf16_f32 v57, v34, v35
    v_exp_f32 v37, v37
    v_mfma_f32_32x32x16_bf16 v[64:79], v[144:147], v[48:51], v[64:79]
    v_exp_f32 v38, v38
    v_cvt_pk_bf16_f32 v58, v36, v37
    v_exp_f32 v39, v39
    v_exp_f32 v40, v40
    v_cvt_pk_bf16_f32 v59, v38, v39
    v_exp_f32 v41, v41
    v_exp_f32 v42, v42
    v_cvt_pk_bf16_f32 v60, v40, v41
    v_mfma_f32_32x32x16_bf16 v[64:79], v[148:151], v[52:55], v[64:79]
    v_exp_f32 v43, v43
    v_exp_f32 v44, v44
    v_cvt_pk_bf16_f32 v61, v42, v43
    v_exp_f32 v45, v45
    v_exp_f32 v46, v46
    v_cvt_pk_bf16_f32 v62, v44, v45
    v_exp_f32 v47, v47
    s_nop 0
    v_cvt_pk_bf16_f32 v63, v46, v47
    s_setprio 3
    s_nop 0
    v_mfma_f32_32x32x16_bf16 v[80:95], v[144:147], v[56:59], v[80:95]
    v_mfma_f32_32x32x16_bf16 v[80:95], v[148:151], v[60:63], v[80:95]
    ds_write_b128 v6, v[64:67]
    ds_write_b128 v6, v[68:71] offset:1024
    ds_write_b32 v8, v72 offset:2048
    ds_write_b32 v10, v3 offset:48
    s_mov_b32 s66, 0
L_xw:
    ds_read_b32 v2, v11 offset:48
    ds_read_b128 v[48:51], v7
    ds_read_b128 v[52:55], v7 offset:1024
    ds_read_b32 v56, v9 offset:2048
    s_add_u32 s66, s66, 1
    s_waitcnt lgkmcnt(0)
    v_readfirstlane_b32 s67, v2
    s_cmp_ge_u32 s66, 2097152
    s_cbranch_scc1 L_xe
    s_cmp_eq_u32 s67, 0
    s_cbranch_scc1 L_xw
L_xe:
    v_add_f32 v80, v80, v48
    v_add_f32 v81, v81, v49
    v_add_f32 v82, v82, v50
    v_add_f32 v83, v83, v51
    v_add_f32 v84, v84, v52
    v_add_f32 v85, v85, v53
    v_add_f32 v86, v86, v54
    v_add_f32 v87, v87, v55
    v_add_f32 v88, v88, v56
    v_rcp_f32 v48, v88
    v_add_f32 v50, abs(v80), abs(v81)
    v_add_f32 v51, abs(v82), abs(v83)
    v_add_f32 v52, abs(v84), abs(v85)
    v_add_f32 v53, abs(v86), abs(v87)
    v_cmp_le_f32 s[28:29], s44, v88
    v_add_f32 v50, v50, v51
    v_add_f32 v52, v52, v53
    v_cmp_ge_f32 s[30:31], s45, v88
    v_add_f32 v50, v50, v52
    v_cmp_ge_f32 s[32:33], s46, v50
    s_and_b64 s[28:29], s[28:29], s[30:31]
    s_nop 0
    s_and_b64 s[28:29], s[28:29], s[32:33]
    s_cmp_eq_u64 s[28:29], -1
    s_cbranch_scc0 L_slow
L_fin:
    v_mul_f32 v80, v80, v48
    v_mul_f32 v81, v81, v48
    v_mul_f32 v82, v82, v48
    v_mul_f32 v83, v83, v48
    v_mul_f32 v84, v84, v48
    v_mul_f32 v85, v85, v48
    v_mul_f32 v86, v86, v48
    v_mul_f32 v87, v87, v48
    v_cvt_pk_bf16_f32 v52, v80, v81
    v_cvt_pk_bf16_f32 v53, v82, v83
    v_cvt_pk_bf16_f32 v54, v84, v85
    v_cvt_pk_bf16_f32 v55, v86, v87
    buffer_store_dwordx4 v[52:55], v5, s[8:11], s54 offen sc1
    v_mov_b32 v3, 1
    s_mov_b64 exec, 1
    ds_add_u32 v13, v3 offset:16
    s_mov_b64 exec, -1
    s_cmp_ge_u32 s3, 8
    s_cbranch_scc1 L_bend
    s_load_dwordx4 s[32:35], s[0:1], 88
    s_waitcnt lgkmcnt(0)
    s_mov_b32 s16, s34
    s_mov_b32 s17, s35
    s_mov_b32 s18, 0x400000
    s_mov_b32 s19, 0x00020000
    s_lshl_b32 s26, s49, 2
    v_add_u32 v8, s26, v12
    s_waitcnt vmcnt(1)
    v_cmp_eq_u32 vcc, s7, v1
    s_nop 1
    s_cmp_eq_u64 vcc, -1
    s_cbranch_scc1 L_mok
    s_mov_b32 s66, 0
    s_branch L_ft38
L_fp36:
    s_sleep 8
L_ft38:
    buffer_load_dword v1, v163, s[8:11], s52 offen sc1
    s_add_u32 s66, s66, 1
    s_waitcnt vmcnt(0)
    v_cmp_eq_u32 vcc, s7, v1
    s_cmp_ge_u32 s66, 524288
    s_cbranch_scc1 L_fe37
    s_cmp_eq_u64 vcc, -1
    s_cbranch_scc0 L_fp36
L_fe37:
L_mok:
    s_mov_b32 s66, 0
L_sp39:
    ds_read_b32 v3, v12 offset:44
    s_add_u32 s66, s66, 1
    s_waitcnt lgkmcnt(0)
    v_readfirstlane_b32 s67, v3
    s_cmp_ge_u32 s66, 524288
    s_cbranch_scc1 L_se40
    s_cmp_ge_u32 s67, 4
    s_cbranch_scc1 L_se40
    s_sleep 8
    s_branch L_sp39
L_se40:
    ds_read_b64_tr_b16 v[88:89], v160 offset:0
    ds_read_b64_tr_b16 v[90:91], v160 offset:1024
    ds_read_b64_tr_b16 v[92:93], v161 offset:0
    ds_read_b64_tr_b16 v[94:95], v161 offset:1024
    ds_read_b64_tr_b16 v[96:97], v160 offset:2048
    ds_read_b64_tr_b16 v[98:99], v160 offset:3072
    ds_read_b64_tr_b16 v[100:101], v161 offset:2048
    ds_read_b64_tr_b16 v[102:103], v161 offset:3072
    ds_read_b64_tr_b16 v[104:105], v160 offset:4096
    ds_read_b64_tr_b16 v[106:107], v160 offset:5120
    ds_read_b64_tr_b16 v[108:109], v161 offset:4096
    ds_read_b64_tr_b16 v[110:111], v161 offset:5120
    ds_read_b64_tr_b16 v[112:113], v160 offset:6144
    ds_read_b64_tr_b16 v[114:115], v160 offset:7168
    ds_read_b64_tr_b16 v[116:117], v161 offset:6144
    ds_read_b64_tr_b16 v[118:119], v161 offset:7168
    ds_read_b64_tr_b16 v[120:121], v160 offset:8192
    ds_read_b64_tr_b16 v[122:123], v160 offset:9216
    ds_read_b64_tr_b16 v[124:125], v161 offset:8192
    ds_read_b64_tr_b16 v[126:127], v161 offset:9216
    ds_read_b64_tr_b16 v[128:129], v160 offset:10240
    ds_read_b64_tr_b16 v[130:131], v160 offset:11264
    ds_read_b64_tr_b16 v[132:133], v161 offset:10240
    ds_read_b64_tr_b16 v[134:135], v161 offset:11264
    ds_read_b64_tr_b16 v[136:137], v160 offset:12288
    ds_read_b64_tr_b16 v[138:139], v160 offset:13312
    ds_read_b64_tr_b16 v[140:141], v161 offset:12288
    ds_read_b64_tr_b16 v[142:143], v161 offset:13312
    ds_read_b64_tr_b16 v[144:145], v160 offset:14336
    ds_read_b64_tr_b16 v[146:147], v160 offset:15360
    ds_read_b64_tr_b16 v[148:149], v161 offset:14336
    ds_read_b64_tr_b16 v[150:151], v161 offset:15360
    s_mov_b32 s66, 0
L_sp41:
    ds_read_b32 v3, v12 offset:88
    s_add_u32 s66, s66, 1
    s_waitcnt lgkmcnt(0)
    v_readfirstlane_b32 s67, v3
    s_cmp_ge_u32 s66, 524288
    s_cbranch_scc1 L_se42
    s_cmp_ge_u32 s67, 659456
    s_cbranch_scc1 L_se42
    s_sleep 3
    s_branch L_sp41
L_se42:
    v_mov_b32 v20, 0
    v_mov_b32 v21, 0
    v_mov_b32 v22, 0
    v_mov_b32 v23, 0
    v_mov_b32 v24, 0
    v_mov_b32 v25, 0
    v_mov_b32 v26, 0
    v_mov_b32 v27, 0
    v_mov_b32 v28, 0
    v_mov_b32 v29, 0
    v_mov_b32 v30, 0
    v_mov_b32 v31, 0
    v_mov_b32 v32, 0
    v_mov_b32 v33, 0
    v_mov_b32 v34, 0
    v_mov_b32 v35, 0
    v_mov_b32 v36, 0
    v_mov_b32 v37, 0
    v_mov_b32 v38, 0
    v_mov_b32 v39, 0
    v_mov_b32 v40, 0
    v_mov_b32 v41, 0
    v_mov_b32 v42, 0
    v_mov_b32 v43, 0
    v_mov_b32 v44, 0
    v_mov_b32 v45, 0
    v_mov_b32 v46, 0
    v_mov_b32 v47, 0
    v_mov_b32 v48, 0
    v_mov_b32 v49, 0
    v_mov_b32 v50, 0
    v_mov_b32 v51, 0
    s_mov_b32 s23, 0
    s_mov_b32 s66, 0
L_hp43:
    s_bitcmp1_b32 s23, 0
    s_cbranch_scc1 L_ls45
    s_add_u32 s38, s51, 0
    s_and_b32 s38, s38, 7
    s_lshl_b32 s30, s38, 12
    s_add_u32 s30, s30, s53
    buffer_load_dwordx4 v[56:59], v5, s[8:11], s30 offen sc1
    buffer_load_dwordx4 v[60:63], v5, s[8:11], s30 offen offset:1024 sc1
L_ls45:
    s_bitcmp1_b32 s23, 1
    s_cbranch_scc1 L_ls46
    s_add_u32 s38, s51, 1
    s_and_b32 s38, s38, 7
    s_lshl_b32 s30, s38, 12
    s_add_u32 s30, s30, s53
    buffer_load_dwordx4 v[64:67], v5, s[8:11], s30 offen sc1
    buffer_load_dwordx4 v[68:71], v5, s[8:11], s30 offen offset:1024 sc1
L_ls46:
    s_bitcmp1_b32 s23, 2
    s_cbranch_scc1 L_ls47
    s_add_u32 s38, s51, 2
    s_and_b32 s38, s38, 7
    s_lshl_b32 s30, s38, 12
    s_add_u32 s30, s30, s53
    buffer_load_dwordx4 v[72:75], v5, s[8:11], s30 offen sc1
    buffer_load_dwordx4 v[76:79], v5, s[8:11], s30 offen offset:1024 sc1
L_ls47:
    s_bitcmp1_b32 s23, 3
    s_cbranch_scc1 L_ls48
    s_add_u32 s38, s51, 3
    s_and_b32 s38, s38, 7
    s_lshl_b32 s30, s38, 12
    s_add_u32 s30, s30, s53
    buffer_load_dwordx4 v[80:83], v5, s[8:11], s30 offen sc1
    buffer_load_dwordx4 v[84:87], v5, s[8:11], s30 offen offset:1024 sc1
L_ls48:
    s_add_u32 s66, s66, 1
    s_waitcnt vmcnt(0) lgkmcnt(0)
    s_bitcmp1_b32 s23, 0
    s_cbranch_scc1 L_lc49
    v_max3_u32 v1, v56, v57, v58
    v_max3_u32 v2, v59, v60, v61
    v_max3_u32 v1, v1, v62, v63
    v_max_u32 v1, v1, v2
    v_cmp_eq_u32 vcc, -1, v1
    s_cmp_ge_u32 s66, 524288
    s_cbranch_scc1 L_lg50
    s_cbranch_vccnz L_lc49
L_lg50:
    s_bitset1_b32 s23, 0
    v_mfma_f32_32x32x16_bf16 v[20:35], v[88:91], v[56:59], v[20:35]
    v_mfma_f32_32x32x16_bf16 v[20:35], v[96:99], v[60:63], v[20:35]
    v_mfma_f32_32x32x16_bf16 v[36:51], v[92:95], v[56:59], v[36:51]
    v_mfma_f32_32x32x16_bf16 v[36:51], v[100:103], v[60:63], v[36:51]
L_lc49:
    s_bitcmp1_b32 s23, 1
    s_cbranch_scc1 L_lc51
    v_max3_u32 v1, v64, v65, v66
    v_max3_u32 v2, v67, v68, v69
    v_max3_u32 v1, v1, v70, v71
    v_max_u32 v1, v1, v2
    v_cmp_eq_u32 vcc, -1, v1
    s_cmp_ge_u32 s66, 524288
    s_cbranch_scc1 L_lg52
    s_cbranch_vccnz L_lc51
L_lg52:
    s_bitset1_b32 s23, 1
    v_mfma_f32_32x32x16_bf16 v[20:35], v[104:107], v[64:67], v[20:35]
    v_mfma_f32_32x32x16_bf16 v[20:35], v[112:115], v[68:71], v[20:35]
    v_mfma_f32_32x32x16_bf16 v[36:51], v[108:111], v[64:67], v[36:51]
    v_mfma_f32_32x32x16_bf16 v[36:51], v[116:119], v[68:71], v[36:51]
L_lc51:
    s_bitcmp1_b32 s23, 2
    s_cbranch_scc1 L_lc53
    v_max3_u32 v1, v72, v73, v74
    v_max3_u32 v2, v75, v76, v77
    v_max3_u32 v1, v1, v78, v79
    v_max_u32 v1, v1, v2
    v_cmp_eq_u32 vcc, -1, v1
    s_cmp_ge_u32 s66, 524288
    s_cbranch_scc1 L_lg54
    s_cbranch_vccnz L_lc53
L_lg54:
    s_bitset1_b32 s23, 2
    v_mfma_f32_32x32x16_bf16 v[20:35], v[120:123], v[72:75], v[20:35]
    v_mfma_f32_32x32x16_bf16 v[20:35], v[128:131], v[76:79], v[20:35]
    v_mfma_f32_32x32x16_bf16 v[36:51], v[124:127], v[72:75], v[36:51]
    v_mfma_f32_32x32x16_bf16 v[36:51], v[132:135], v[76:79], v[36:51]
L_lc53:
    s_bitcmp1_b32 s23, 3
    s_cbranch_scc1 L_lc55
    v_max3_u32 v1, v80, v81, v82
    v_max3_u32 v2, v83, v84, v85
    v_max3_u32 v1, v1, v86, v87
    v_max_u32 v1, v1, v2
    v_cmp_eq_u32 vcc, -1, v1
    s_cmp_ge_u32 s66, 524288
    s_cbranch_scc1 L_lg56
    s_cbranch_vccnz L_lc55
L_lg56:
    s_bitset1_b32 s23, 3
    v_mfma_f32_32x32x16_bf16 v[20:35], v[136:139], v[80:83], v[20:35]
    v_mfma_f32_32x32x16_bf16 v[20:35], v[144:147], v[84:87], v[20:35]
    v_mfma_f32_32x32x16_bf16 v[36:51], v[140:143], v[80:83], v[36:51]
    v_mfma_f32_32x32x16_bf16 v[36:51], v[148:151], v[84:87], v[36:51]
L_lc55:
    s_cmp_eq_u32 s23, 15
    s_cbranch_scc1 L_he44
    s_sleep 8
    s_branch L_hp43
L_he44:
    ds_read_b64_tr_b16 v[88:89], v160 offset:32768
    ds_read_b64_tr_b16 v[90:91], v160 offset:33792
    ds_read_b64_tr_b16 v[92:93], v161 offset:32768
    ds_read_b64_tr_b16 v[94:95], v161 offset:33792
    ds_read_b64_tr_b16 v[96:97], v160 offset:34816
    ds_read_b64_tr_b16 v[98:99], v160 offset:35840
    ds_read_b64_tr_b16 v[100:101], v161 offset:34816
    ds_read_b64_tr_b16 v[102:103], v161 offset:35840
    ds_read_b64_tr_b16 v[104:105], v160 offset:36864
    ds_read_b64_tr_b16 v[106:107], v160 offset:37888
    ds_read_b64_tr_b16 v[108:109], v161 offset:36864
    ds_read_b64_tr_b16 v[110:111], v161 offset:37888
    ds_read_b64_tr_b16 v[112:113], v160 offset:38912
    ds_read_b64_tr_b16 v[114:115], v160 offset:39936
    ds_read_b64_tr_b16 v[116:117], v161 offset:38912
    ds_read_b64_tr_b16 v[118:119], v161 offset:39936
    ds_read_b64_tr_b16 v[120:121], v160 offset:40960
    ds_read_b64_tr_b16 v[122:123], v160 offset:41984
    ds_read_b64_tr_b16 v[124:125], v161 offset:40960
    ds_read_b64_tr_b16 v[126:127], v161 offset:41984
    ds_read_b64_tr_b16 v[128:129], v160 offset:43008
    ds_read_b64_tr_b16 v[130:131], v160 offset:44032
    ds_read_b64_tr_b16 v[132:133], v161 offset:43008
    ds_read_b64_tr_b16 v[134:135], v161 offset:44032
    ds_read_b64_tr_b16 v[136:137], v160 offset:45056
    ds_read_b64_tr_b16 v[138:139], v160 offset:46080
    ds_read_b64_tr_b16 v[140:141], v161 offset:45056
    ds_read_b64_tr_b16 v[142:143], v161 offset:46080
    ds_read_b64_tr_b16 v[144:145], v160 offset:47104
    ds_read_b64_tr_b16 v[146:147], v160 offset:48128
    ds_read_b64_tr_b16 v[148:149], v161 offset:47104
    ds_read_b64_tr_b16 v[150:151], v161 offset:48128
    s_add_u32 s53, s53, 2048
    s_mov_b32 s66, 0
L_sp57:
    ds_read_b32 v3, v12 offset:44
    s_add_u32 s66, s66, 1
    s_waitcnt lgkmcnt(0)
    v_readfirstlane_b32 s67, v3
    s_cmp_ge_u32 s66, 524288
    s_cbranch_scc1 L_se58
    s_cmp_ge_u32 s67, 4
    s_cbranch_scc1 L_se58
    s_sleep 2
    s_branch L_sp57
L_se58:
    s_mov_b32 s66, 0
L_sp59:
    ds_read_b32 v3, v12 offset:20
    s_add_u32 s66, s66, 1
    s_waitcnt lgkmcnt(0)
    v_readfirstlane_b32 s67, v3
    s_cmp_ge_u32 s66, 524288
    s_cbranch_scc1 L_se60
    s_cmp_ge_u32 s67, 4
    s_cbranch_scc1 L_se60
    s_sleep 2
    s_branch L_sp59
L_se60:
    s_mov_b32 s23, 0
    s_mov_b32 s66, 0
L_hp61:
    s_bitcmp1_b32 s23, 0
    s_cbranch_scc1 L_ls63
    s_add_u32 s38, s51, 0
    s_and_b32 s38, s38, 7
    s_lshl_b32 s30, s38, 12
    s_add_u32 s30, s30, s53
    buffer_load_dwordx4 v[56:59], v5, s[8:11], s30 offen sc1
    buffer_load_dwordx4 v[60:63], v5, s[8:11], s30 offen offset:1024 sc1
L_ls63:
    s_bitcmp1_b32 s23, 1
    s_cbranch_scc1 L_ls64
    s_add_u32 s38, s51, 1
    s_and_b32 s38, s38, 7
    s_lshl_b32 s30, s38, 12
    s_add_u32 s30, s30, s53
    buffer_load_dwordx4 v[64:67], v5, s[8:11], s30 offen sc1
    buffer_load_dwordx4 v[68:71], v5, s[8:11], s30 offen offset:1024 sc1
L_ls64:
    s_bitcmp1_b32 s23, 2
    s_cbranch_scc1 L_ls65
    s_add_u32 s38, s51, 2
    s_and_b32 s38, s38, 7
    s_lshl_b32 s30, s38, 12
    s_add_u32 s30, s30, s53
    buffer_load_dwordx4 v[72:75], v5, s[8:11], s30 offen sc1
    buffer_load_dwordx4 v[76:79], v5, s[8:11], s30 offen offset:1024 sc1
L_ls65:
    s_bitcmp1_b32 s23, 3
    s_cbranch_scc1 L_ls66
    s_add_u32 s38, s51, 3
    s_and_b32 s38, s38, 7
    s_lshl_b32 s30, s38, 12
    s_add_u32 s30, s30, s53
    buffer_load_dwordx4 v[80:83], v5, s[8:11], s30 offen sc1
    buffer_load_dwordx4 v[84:87], v5, s[8:11], s30 offen offset:1024 sc1
L_ls66:
    s_add_u32 s66, s66, 1
    s_waitcnt vmcnt(0) lgkmcnt(0)
    s_bitcmp1_b32 s23, 0
    s_cbranch_scc1 L_lc67
    v_max3_u32 v1, v56, v57, v58
    v_max3_u32 v2, v59, v60, v61
    v_max3_u32 v1, v1, v62, v63
    v_max_u32 v1, v1, v2
    v_cmp_eq_u32 vcc, -1, v1
    s_cmp_ge_u32 s66, 524288
    s_cbranch_scc1 L_lg68
    s_cbranch_vccnz L_lc67
L_lg68:
    s_bitset1_b32 s23, 0
    v_mfma_f32_32x32x16_bf16 v[20:35], v[88:91], v[56:59], v[20:35]
    v_mfma_f32_32x32x16_bf16 v[20:35], v[96:99], v[60:63], v[20:35]
    v_mfma_f32_32x32x16_bf16 v[36:51], v[92:95], v[56:59], v[36:51]
    v_mfma_f32_32x32x16_bf16 v[36:51], v[100:103], v[60:63], v[36:51]
L_lc67:
    s_bitcmp1_b32 s23, 1
    s_cbranch_scc1 L_lc69
    v_max3_u32 v1, v64, v65, v66
    v_max3_u32 v2, v67, v68, v69
    v_max3_u32 v1, v1, v70, v71
    v_max_u32 v1, v1, v2
    v_cmp_eq_u32 vcc, -1, v1
    s_cmp_ge_u32 s66, 524288
    s_cbranch_scc1 L_lg70
    s_cbranch_vccnz L_lc69
L_lg70:
    s_bitset1_b32 s23, 1
    v_mfma_f32_32x32x16_bf16 v[20:35], v[104:107], v[64:67], v[20:35]
    v_mfma_f32_32x32x16_bf16 v[20:35], v[112:115], v[68:71], v[20:35]
    v_mfma_f32_32x32x16_bf16 v[36:51], v[108:111], v[64:67], v[36:51]
    v_mfma_f32_32x32x16_bf16 v[36:51], v[116:119], v[68:71], v[36:51]
L_lc69:
    s_bitcmp1_b32 s23, 2
    s_cbranch_scc1 L_lc71
    v_max3_u32 v1, v72, v73, v74
    v_max3_u32 v2, v75, v76, v77
    v_max3_u32 v1, v1, v78, v79
    v_max_u32 v1, v1, v2
    v_cmp_eq_u32 vcc, -1, v1
    s_cmp_ge_u32 s66, 524288
    s_cbranch_scc1 L_lg72
    s_cbranch_vccnz L_lc71
L_lg72:
    s_bitset1_b32 s23, 2
    v_mfma_f32_32x32x16_bf16 v[20:35], v[120:123], v[72:75], v[20:35]
    v_mfma_f32_32x32x16_bf16 v[20:35], v[128:131], v[76:79], v[20:35]
    v_mfma_f32_32x32x16_bf16 v[36:51], v[124:127], v[72:75], v[36:51]
    v_mfma_f32_32x32x16_bf16 v[36:51], v[132:135], v[76:79], v[36:51]
L_lc71:
    s_bitcmp1_b32 s23, 3
    s_cbranch_scc1 L_lc73
    v_max3_u32 v1, v80, v81, v82
    v_max3_u32 v2, v83, v84, v85
    v_max3_u32 v1, v1, v86, v87
    v_max_u32 v1, v1, v2
    v_cmp_eq_u32 vcc, -1, v1
    s_cmp_ge_u32 s66, 524288
    s_cbranch_scc1 L_lg74
    s_cbranch_vccnz L_lc73
L_lg74:
    s_bitset1_b32 s23, 3
    v_mfma_f32_32x32x16_bf16 v[20:35], v[136:139], v[80:83], v[20:35]
    v_mfma_f32_32x32x16_bf16 v[20:35], v[144:147], v[84:87], v[20:35]
    v_mfma_f32_32x32x16_bf16 v[36:51], v[140:143], v[80:83], v[36:51]
    v_mfma_f32_32x32x16_bf16 v[36:51], v[148:151], v[84:87], v[36:51]
L_lc73:
    s_cmp_eq_u32 s23, 15
    s_cbranch_scc1 L_he62
    s_sleep 6
    s_branch L_hp61
L_he62:
    v_mov_b32 v3, 1
    s_nop 6
    ds_write_b128 v164, v[20:23] offset:0
    ds_write_b128 v164, v[24:27] offset:1024
    ds_write_b128 v164, v[28:31] offset:2048
    ds_write_b128 v164, v[32:35] offset:3072
    ds_write_b32 v166, v3 offset:96
    s_mov_b32 s66, 0
L_rw:
    ds_read_b32 v2, v167 offset:96
    ds_read_b128 v[64:67], v165 offset:0
    ds_read_b128 v[68:71], v165 offset:1024
    ds_read_b128 v[72:75], v165 offset:2048
    ds_read_b128 v[76:79], v165 offset:3072
    s_add_u32 s66, s66, 1
    s_waitcnt lgkmcnt(0)
    v_readfirstlane_b32 s67, v2
    s_cmp_ge_u32 s66, 2097152
    s_cbranch_scc1 L_re
    s_cmp_eq_u32 s67, 0
    s_cbranch_scc1 L_rw
L_re:
    v_add_f32 v64, v36, v64
    v_add_f32 v65, v37, v65
    v_add_f32 v66, v38, v66
    v_add_f32 v67, v39, v67
    v_add_f32 v68, v40, v68
    v_add_f32 v69, v41, v69
    v_add_f32 v70, v42, v70
    v_add_f32 v71, v43, v71
    v_add_f32 v72, v44, v72
    v_add_f32 v73, v45, v73
    v_add_f32 v74, v46, v74
    v_add_f32 v75, v47, v75
    v_add_f32 v76, v48, v76
    v_add_f32 v77, v49, v77
    v_add_f32 v78, v50, v78
    v_add_f32 v79, v51, v79
    v_cvt_pk_bf16_f32 v80, v64, v65
    v_cvt_pk_bf16_f32 v81, v66, v67
    v_cvt_pk_bf16_f32 v82, v68, v69
    v_cvt_pk_bf16_f32 v83, v70, v71
    v_cvt_pk_bf16_f32 v84, v72, v73
    v_cvt_pk_bf16_f32 v85, v74, v75
    v_cvt_pk_bf16_f32 v86, v76, v77
    v_cvt_pk_bf16_f32 v87, v78, v79
    buffer_store_dwordx4 v[80:83], v162, s[16:19], s50 offen
    buffer_store_dwordx4 v[84:87], v162, s[16:19], s50 offen offset:16
L_bend:
    s_endpgm
L_slow:
    v_mov_b32 v58, 0xff800000
    s_mov_b32 s42, 0
L_s1:
    buffer_load_dwordx4 v[104:107], v14, s[8:11], s42 offen sc1
    s_waitcnt vmcnt(0)
    v_mfma_f32_32x32x16_bf16 v[16:31], v[104:107], v[100:103], 0
    s_nop 15
    v_max3_f32 v58, v58, v16, v17
    v_max3_f32 v58, v58, v18, v19
    v_max3_f32 v58, v58, v20, v21
    v_max3_f32 v58, v58, v22, v23
    v_max3_f32 v58, v58, v24, v25
    v_max3_f32 v58, v58, v26, v27
    v_max3_f32 v58, v58, v28, v29
    v_max3_f32 v58, v58, v30, v31
    s_add_u32 s42, s42, 1024
    s_cmp_lt_u32 s42, 0x10000
    s_cbranch_scc1 L_s1
    v_mov_b32 v59, v58
    s_nop 1
    v_permlane32_swap_b32 v58, v59
    s_nop 1
    v_max_f32 v58, v58, v59
    v_sub_f32 v64, 0, v58
    v_mov_b32 v80, 0
    v_sub_f32 v65, 0, v58
    v_mov_b32 v81, 0
    v_sub_f32 v66, 0, v58
    v_mov_b32 v82, 0
    v_sub_f32 v67, 0, v58
    v_mov_b32 v83, 0
    v_sub_f32 v68, 0, v58
    v_mov_b32 v84, 0
    v_sub_f32 v69, 0, v58
    v_mov_b32 v85, 0
    v_sub_f32 v70, 0, v58
    v_mov_b32 v86, 0
    v_sub_f32 v71, 0, v58
    v_mov_b32 v87, 0
    v_sub_f32 v72, 0, v58
    v_mov_b32 v88, 0
    v_sub_f32 v73, 0, v58
    v_mov_b32 v89, 0
    v_sub_f32 v74, 0, v58
    v_mov_b32 v90, 0
    v_sub_f32 v75, 0, v58
    v_mov_b32 v91, 0
    v_sub_f32 v76, 0, v58
    v_mov_b32 v92, 0
    v_sub_f32 v77, 0, v58
    v_mov_b32 v93, 0
    v_sub_f32 v78, 0, v58
    v_mov_b32 v94, 0
    v_sub_f32 v79, 0, v58
    v_mov_b32 v95, 0
    s_mov_b32 s42, 0
L_s2:
    buffer_load_dwordx4 v[104:107], v14, s[8:11], s42 offen sc1
    s_mov_b64 exec, s[40:41]
    buffer_load_dwordx4 v[120:123], v15, s[8:11], s42 offen sc1
    buffer_load_dwordx4 v[124:127], v15, s[8:11], s42 offen offset:512 sc1
    s_mov_b64 exec, -1
    s_waitcnt vmcnt(0)
    v_mfma_f32_32x32x16_bf16 v[16:31], v[104:107], v[100:103], v[64:79]
    s_nop 15
    v_exp_f32 v16, v16
    v_exp_f32 v17, v17
    v_exp_f32 v18, v18
    v_exp_f32 v19, v19
    v_exp_f32 v20, v20
    v_exp_f32 v21, v21
    v_exp_f32 v22, v22
    v_exp_f32 v23, v23
    v_exp_f32 v24, v24
    v_exp_f32 v25, v25
    v_exp_f32 v26, v26
    v_exp_f32 v27, v27
    v_exp_f32 v28, v28
    v_exp_f32 v29, v29
    v_exp_f32 v30, v30
    v_exp_f32 v31, v31
    s_nop 0
    v_cvt_pk_bf16_f32 v48, v16, v17
    v_cvt_pk_bf16_f32 v49, v18, v19
    v_cvt_pk_bf16_f32 v50, v20, v21
    v_cvt_pk_bf16_f32 v51, v22, v23
    v_cvt_pk_bf16_f32 v52, v24, v25
    v_cvt_pk_bf16_f32 v53, v26, v27
    v_cvt_pk_bf16_f32 v54, v28, v29
    v_cvt_pk_bf16_f32 v55, v30, v31
    s_nop 1
    v_mfma_f32_32x32x16_bf16 v[80:95], v[120:123], v[48:51], v[80:95]
    v_mfma_f32_32x32x16_bf16 v[80:95], v[124:127], v[52:55], v[80:95]
    s_add_u32 s42, s42, 1024
    s_cmp_lt_u32 s42, 0x10000
    s_cbranch_scc1 L_s2
    s_nop 15
    v_rcp_f32 v48, v88
    s_nop 0
    s_branch L_fin
L_end:
    s_endpgm
.p2align 8
.fill 1024, 4, 0xbf800000
.section .rodata,"a"
.p2align 6
.amdhsa_kernel concat_heads__ssm_conv_s4__softmax_full_mha__prompt_kernel
  .amdhsa_next_free_vgpr 168
  .amdhsa_next_free_sgpr 102
  .amdhsa_accum_offset 168
  .amdhsa_group_segment_fixed_size 0
  .amdhsa_kernarg_size 120
  .amdhsa_user_sgpr_count 2
  .amdhsa_user_sgpr_kernarg_segment_ptr 1
  .amdhsa_system_sgpr_workgroup_id_x 1
.end_amdhsa_kernel
```
